```python
import torch

def _softmax(x, axis=-1):
    return torch.softmax(x, dim=axis)

def _gelu(x):
    return torch.nn.functional.gelu(x, approximate='tanh')

def _silu(x):
    return torch.nn.functional.silu(x)

def _sigmoid(x):
    return torch.sigmoid(x)

def _layernorm(x, axis=-1, eps=1e-05):
    m = x.mean(dim=axis, keepdim=True)
    v = x.var(dim=axis, keepdim=True, unbiased=False)
    return (x - m) / torch.sqrt(v + eps)

def _scatter_add(tgt, idx, src, axis=0):
    return tgt.clone().index_add_(axis, idx, src)

def _segment_sum(src, seg, n):
    out = torch.zeros((n,) + src.shape[1:], dtype=src.dtype)
    return out.index_add_(0, seg, src)

def _pad(x, pw):
    flat = tuple((v for pair in reversed(pw) for v in pair))
    return torch.nn.functional.pad(x, flat)
kernel_name = 'adaLN_cond__gqa_block_cached__glu_gated_bilinear__decode'

def setup_inputs():

    _w = lambda a: (lambda t: t.to(torch.bfloat16) if t.is_floating_point() else t)(torch.as_tensor(a))

    def _A_setup():
        B, Sq, D = (1, 1, 512)
        Hq, Hkv, Sk, Dh = (32, 32, 4096, 128)
        assert Hq % Hkv == 0, (Hq, Hkv)
        return {'x': _w((lambda *s: torch.randn(*s, dtype=torch.bfloat16) * 0.05)(B, Sq, D)), 'k_cache': _w((lambda *s: torch.randn(*s, dtype=torch.bfloat16) * 0.8)(B, Hkv, Sk, Dh)), 'v_cache': _w((lambda *s: torch.randn(*s, dtype=torch.bfloat16) * 3.2)(B, Hkv, Sk, Dh)), 'wq': _w((lambda *s: torch.randn(*s, dtype=torch.bfloat16) * 0.8)(D, Hq * Dh) * D ** (-0.5)), 'wo': _w((lambda *s: torch.randn(*s, dtype=torch.bfloat16) * 3.2)(Hq * Dh, D) * (Hq * Dh) ** (-0.5))}
    _A_in = _A_setup()

    def _B_setup():
        B, S, D, F = (1, 1, 512, 1376)
        return {'x': _w((lambda *s: torch.randn(*s, dtype=torch.bfloat16) * 0.05)(B, S, D)), 'w_gate': _w((lambda *s: torch.randn(*s, dtype=torch.bfloat16) * 3.2)(D, F) * D ** (-0.5)), 'w_up': _w((lambda *s: torch.randn(*s, dtype=torch.bfloat16) * 3.2)(D, F) * D ** (-0.5)), 'w_down': _w((lambda *s: torch.randn(*s, dtype=torch.bfloat16) * 3.2)(F, D) * F ** (-0.5))}
    _B_in = _B_setup()
    return {'A_x': _A_in['x'], 'A_k_cache': _A_in['k_cache'], 'A_v_cache': _A_in['v_cache'], 'A_wq': _A_in['wq'], 'A_wo': _A_in['wo'], 'B_x': _B_in['x'], 'B_w_gate': _B_in['w_gate'], 'B_w_up': _B_in['w_up'], 'B_w_down': _B_in['w_down'], 'c': _w((lambda *s: torch.randn(*s, dtype=torch.bfloat16) * 0.4)(1, 512) * 8.0), 'w_mod': _w((lambda *s: torch.randn(*s, dtype=torch.bfloat16) * 0.4)(512, 6 * 512) * 512 ** (-0.5) * 8.0)}

def reference(A_x, A_k_cache, A_v_cache, A_wq, A_wo, B_x, B_w_gate, B_w_up, B_w_down, c, w_mod):

    def _A_ref(x, k_cache, v_cache, wq, wo):
        B, Sq, D = x.shape
        Hq, Dh = (32, 128)
        Hkv = k_cache.shape[1]
        rep = Hq // Hkv
        q = (lambda x, *d: x.permute(*d))((x @ wq).reshape(B, Sq, Hq, Dh), 0, 2, 1, 3)
        k = (lambda x, n, axis: torch.repeat_interleave(x, n, dim=axis))(k_cache, rep, axis=1)
        v = (lambda x, n, axis: torch.repeat_interleave(x, n, dim=axis))(v_cache, rep, axis=1)
        scores = torch.einsum('bhqd,bhkd->bhqk', q, k) * Dh ** (-0.5)
        p = _softmax(scores, axis=-1)
        o = torch.einsum('bhqk,bhkd->bhqd', p, v)
        return (lambda x, *d: x.permute(*d))(o, 0, 2, 1, 3).reshape(B, Sq, Hq * Dh) @ wo

    def _B_ref(x, w_gate, w_up, w_down):
        g = torch.einsum('bsd,df->bsf', x, w_gate)
        u = torch.einsum('bsd,df->bsf', x, w_up)
        h = g * u
        return torch.einsum('bsf,fd->bsd', h, w_down)
    x = A_x
    mod = (_silu(c) @ w_mod).reshape(c.shape[0], 6, 1, -1)
    sa, ca, ga, sb, cb, gb = (mod[:, 0].clone(), mod[:, 1].clone(), mod[:, 2].clone(), mod[:, 3].clone(), mod[:, 4].clone(), mod[:, 5].clone())
    h = _layernorm(x, axis=-1) * (1 + ca) + sa
    x = x + ga * _A_ref(h, A_k_cache, A_v_cache, A_wq, A_wo)
    h = _layernorm(x, axis=-1) * (1 + cb) + sb
    x = x + gb * _B_ref(h, B_w_gate, B_w_up, B_w_down)
    return x
```

```asm
; @launch grid=(256,1,1) block=(768,1,1) lds=15360
.amdgcn_target "amdgcn-amd-amdhsa--gfx950"
.text
.globl adaLN_cond__gqa_block_cached__glu_gated_bilinear__decode_kernel
.p2align 8
.type adaLN_cond__gqa_block_cached__glu_gated_bilinear__decode_kernel,@function
adaLN_cond__gqa_block_cached__glu_gated_bilinear__decode_kernel:
s_cmp_ge_u32 s2, 256
s_cbranch_scc1 L_done
s_load_dwordx16 s[64:79], s[0:1], 0
s_load_dwordx8 s[80:87], s[0:1], 64
s_load_dwordx4 s[88:91], s[0:1], 96
s_getpc_b64 s[92:93]
L_pc:
s_lshl_b32 s9, s2, 6
s_and_b32 s9, s9, 0x3e00
v_lshl_add_u32 v162, v0, 7, s9
v_min_u32 v162, L_done-L_pc, v162
v_cmp_gt_u32 vcc, 4, v0
s_and_saveexec_b64 s[94:95], vcc
s_cbranch_execz L_nopf
global_load_dword v163, v162, s[92:93]
L_nopf:
s_mov_b64 exec, -1
v_readfirstlane_b32 s3, v0
v_and_b32 v1, 63, v0
v_lshlrev_b32 v11, 4, v1
s_lshr_b32 s3, s3, 6
s_cmp_lt_u32 s3, 4
s_cbranch_scc1 L_helper
s_and_b32 s24, s2, 7
s_lshl_b32 s24, s24, 5
s_and_b32 s9, s2, 0x18
s_add_u32 s24, s24, s9
s_lshl_b32 s24, s24, 17
s_sub_u32 s26, s3, 4
s_and_b32 s9, s26, 3
s_lshl_b32 s9, s9, 10
s_add_u32 s24, s24, s9
s_and_b32 s9, s26, 4
s_lshl_b32 s9, s9, 11
s_add_u32 s24, s24, s9
s_and_b32 s9, s2, 32
s_lshl_b32 s9, s9, 9
s_add_u32 s24, s24, s9
s_and_b32 s9, s2, 192
s_lshl_b32 s9, s9, 12
s_add_u32 s24, s24, s9
v_mov_b32 v6, v11
s_mov_b32 s14, 0x2000000
s_mov_b32 s15, 0x20000
s_waitcnt lgkmcnt(0)
s_mov_b64 s[12:13], s[66:67]
s_memrealtime s[44:45]
buffer_load_dwordx4 v[32:35], v6, s[12:15], s24 offen offset:0 nt
s_add_u32 s25, s24, 32768
buffer_load_dwordx4 v[36:39], v6, s[12:15], s25 offen offset:0 nt
s_add_u32 s25, s24, 65536
buffer_load_dwordx4 v[40:43], v6, s[12:15], s25 offen offset:0 nt
L_stream2:
s_mov_b64 s[16:17], s[68:69]
s_mov_b32 s18, 0x2000000
s_mov_b32 s19, 0x20000
v_mov_b32 v0, 0
v_lshlrev_b32 v2, 2, v1
ds_write_b32 v2, v0
s_waitcnt lgkmcnt(0)
v_mov_b32 v2, s44
ds_write_b32 v0, v2 offset:512
s_waitcnt lgkmcnt(0)
s_barrier
s_mov_b32 s34, 5
s_mov_b32 s35, 1
s_mov_b32 s38, 0
s_mov_b32 s37, 3320
s_mov_b32 s27, 0
s_waitcnt vmcnt(2)
s_add_u32 s25, s24, 98304
buffer_load_dwordx4 v[44:47], v6, s[12:15], s25 offen offset:0 nt
s_waitcnt vmcnt(2)
s_add_u32 s25, s24, 131072
buffer_load_dwordx4 v[48:51], v6, s[12:15], s25 offen offset:0 nt
s_call_b64 s[40:41], L_thr
s_add_u32 s25, s24, 163840
buffer_load_dwordx4 v[52:55], v6, s[12:15], s25 offen offset:0 nt
s_call_b64 s[40:41], L_thr
s_add_u32 s25, s24, 196608
buffer_load_dwordx4 v[56:59], v6, s[12:15], s25 offen offset:0 nt
s_call_b64 s[40:41], L_thr
s_add_u32 s25, s24, 229376
buffer_load_dwordx4 v[60:63], v6, s[12:15], s25 offen offset:0 nt
s_call_b64 s[40:41], L_thr
s_add_u32 s25, s24, 4096
buffer_load_dwordx4 v[64:67], v6, s[12:15], s25 offen offset:0 nt
s_call_b64 s[40:41], L_thr
s_add_u32 s25, s24, 36864
buffer_load_dwordx4 v[68:71], v6, s[12:15], s25 offen offset:0 nt
s_call_b64 s[40:41], L_thr
s_add_u32 s25, s24, 69632
buffer_load_dwordx4 v[72:75], v6, s[12:15], s25 offen offset:0 nt
s_call_b64 s[40:41], L_thr
s_add_u32 s25, s24, 102400
buffer_load_dwordx4 v[76:79], v6, s[12:15], s25 offen offset:0 nt
s_call_b64 s[40:41], L_thr
s_add_u32 s25, s24, 135168
buffer_load_dwordx4 v[80:83], v6, s[12:15], s25 offen offset:0 nt
s_call_b64 s[40:41], L_thr
s_add_u32 s25, s24, 167936
buffer_load_dwordx4 v[84:87], v6, s[12:15], s25 offen offset:0 nt
s_call_b64 s[40:41], L_thr
s_add_u32 s25, s24, 200704
buffer_load_dwordx4 v[88:91], v6, s[12:15], s25 offen offset:0 nt
s_call_b64 s[40:41], L_thr
s_add_u32 s25, s24, 233472
buffer_load_dwordx4 v[92:95], v6, s[12:15], s25 offen offset:0 nt
s_call_b64 s[40:41], L_thr
buffer_load_dwordx4 v[96:99], v6, s[16:19], s24 offen offset:0 nt
s_call_b64 s[40:41], L_thr
s_add_u32 s25, s24, 32768
buffer_load_dwordx4 v[100:103], v6, s[16:19], s25 offen offset:0 nt
s_call_b64 s[40:41], L_thr
s_add_u32 s25, s24, 65536
buffer_load_dwordx4 v[104:107], v6, s[16:19], s25 offen offset:0 nt
s_call_b64 s[40:41], L_thr
s_add_u32 s25, s24, 98304
buffer_load_dwordx4 v[108:111], v6, s[16:19], s25 offen offset:0 nt
s_call_b64 s[40:41], L_thr
s_add_u32 s25, s24, 131072
buffer_load_dwordx4 v[112:115], v6, s[16:19], s25 offen offset:0 nt
s_mov_b32 s38, 1
s_call_b64 s[40:41], L_thr
s_add_u32 s25, s24, 163840
buffer_load_dwordx4 v[116:119], v6, s[16:19], s25 offen offset:0 nt
s_call_b64 s[40:41], L_thr
s_add_u32 s25, s24, 196608
buffer_load_dwordx4 v[120:123], v6, s[16:19], s25 offen offset:0 nt
s_call_b64 s[40:41], L_thr
s_add_u32 s25, s24, 229376
buffer_load_dwordx4 v[124:127], v6, s[16:19], s25 offen offset:0 nt
s_call_b64 s[40:41], L_thr
s_add_u32 s25, s24, 4096
buffer_load_dwordx4 v[128:131], v6, s[16:19], s25 offen offset:0 nt
s_call_b64 s[40:41], L_thr
s_add_u32 s25, s24, 36864
buffer_load_dwordx4 v[132:135], v6, s[16:19], s25 offen offset:0 nt
s_call_b64 s[40:41], L_thr
s_add_u32 s25, s24, 69632
buffer_load_dwordx4 v[136:139], v6, s[16:19], s25 offen offset:0 nt
s_call_b64 s[40:41], L_thr
s_add_u32 s25, s24, 102400
buffer_load_dwordx4 v[140:143], v6, s[16:19], s25 offen offset:0 nt
s_call_b64 s[40:41], L_thr
s_add_u32 s25, s24, 135168
buffer_load_dwordx4 v[144:147], v6, s[16:19], s25 offen offset:0 nt
s_call_b64 s[40:41], L_thr
s_add_u32 s25, s24, 167936
buffer_load_dwordx4 v[148:151], v6, s[16:19], s25 offen offset:0 nt
s_call_b64 s[40:41], L_thr
s_add_u32 s25, s24, 200704
buffer_load_dwordx4 v[152:155], v6, s[16:19], s25 offen offset:0 nt
s_call_b64 s[40:41], L_thr
s_add_u32 s25, s24, 233472
buffer_load_dwordx4 v[156:159], v6, s[16:19], s25 offen offset:0 nt
s_branch L_stream3
L_thr:
v_mov_b32 v2, s34
s_add_u32 s34, s34, 1
ds_write_b32 v0, v2 offset:44
s_waitcnt vmcnt(5)
ds_read2_b32 v[2:3], v0 offset0:10 offset1:2
s_memrealtime s[42:43]
s_lshr_b32 s10, s37, 4
s_add_u32 s37, s37, 440
s_waitcnt lgkmcnt(0)
v_readfirstlane_b32 s39, v2
v_readfirstlane_b32 s9, v3
s_lshr_b32 s9, s9, 2
s_and_b32 s9, s9, s38
s_cbranch_scc1 L_qk0
s_cmp_lg_u32 s39, 0
s_cselect_b32 s44, s39, s44
s_sub_u32 s9, s42, s44
s_sub_u32 s27, s9, s10
s_cmp_gt_i32 s27, 80
s_cbranch_scc1 L_thr3
s_waitcnt vmcnt(3)
s_cmp_gt_i32 s27, 50
s_cbranch_scc1 L_thr3
s_waitcnt vmcnt(2)
s_cmp_gt_i32 s27, 0
s_cbranch_scc1 L_thr3
s_waitcnt vmcnt(1)
L_thr3:
s_setpc_b64 s[40:41]
L_qk0:
s_sub_u32 s35, s35, 1
s_cbranch_scc1 L_qk
s_setpc_b64 s[40:41]
L_helper:
s_setprio 2
s_and_b32 s4, s2, 7
s_lshr_b32 s5, s2, 3
s_lshl_b32 s6, s4, 2
s_and_b32 s7, s5, 3
s_add_u32 s6, s6, s7
s_lshr_b32 s7, s5, 2
s_mov_b32 s11, 0xffff0000
s_mov_b32 s22, 0x10000000
s_mov_b32 s23, 0x20000
v_lshrrev_b32 v2, 3, v1
v_and_b32 v3, 7, v1
v_lshlrev_b32 v3, 4, v3
s_lshl_b32 s95, s7, 3
s_add_u32 s95, s95, s4
s_lshl_b32 s35, s95, 7
s_lshl_b32 s95, s95, 2
s_and_b32 s9, s5, 3
s_add_u32 s95, s95, s9
s_lshl_b32 s96, s9, 2
s_add_u32 s96, s96, s3
v_mul_u32_u24 v100, 24576, v2
v_add_u32 v100, v100, v3
v_lshlrev_b32 v101, 3, v2
s_lshl_b32 s34, s96, 6
s_mul_i32 s10, s96, 196608
s_add_u32 s35, s35, s10
s_mov_b32 s14, 0x300000
s_mov_b32 s15, 0x20000
s_mov_b32 s42, 0x400
s_mov_b32 s43, 0x20000
s_mov_b32 s18, 0x400000
s_mov_b32 s19, 0x20000
s_mov_b32 s38, 0x400
s_mov_b32 s39, 0x20000
s_cmp_ge_u32 s95, 192
s_waitcnt lgkmcnt(0)
s_mov_b64 s[12:13], s[84:85]
s_mov_b64 s[40:41], s[82:83]
s_cbranch_scc1 L_nomodld
buffer_load_dwordx2 v[84:85], v101, s[40:43], s34 offen
buffer_load_dwordx4 v[32:35], v100, s[12:15], s35 offen nt
s_addk_i32 s35, 6144
buffer_load_dwordx4 v[36:39], v100, s[12:15], s35 offen nt
s_addk_i32 s35, 6144
buffer_load_dwordx4 v[40:43], v100, s[12:15], s35 offen nt
s_addk_i32 s35, 6144
buffer_load_dwordx4 v[44:47], v100, s[12:15], s35 offen nt
L_nomodld:
s_mov_b64 s[20:21], s[90:91]
s_mov_b64 s[16:17], s[70:71]
s_mov_b64 s[36:37], s[64:65]
s_load_dword s8, s[90:91], 0
v_lshl_add_u32 v104, v2, 15, v3
v_and_b32 v105, 3, v1
v_lshl_add_u32 v105, v2, 2, v105
v_lshlrev_b32 v105, 1, v105
s_lshr_b32 s97, s7, 1
s_lshl_b32 s97, s97, 2
s_add_u32 s97, s97, s3
buffer_load_dwordx4 v[88:91], v11, s[36:39], 0 offen
s_lshl_b32 s9, s97, 6
buffer_load_ushort v92, v105, s[36:39], s9 offen
s_lshl_b32 s34, s97, 18
s_lshl_b32 s10, s6, 8
s_add_u32 s34, s34, s10
s_and_b32 s10, s7, 1
s_lshl_b32 s10, s10, 7
s_add_u32 s34, s34, s10
buffer_load_dwordx4 v[48:51], v104, s[16:19], s34 offen nt
s_addk_i32 s34, 8192
buffer_load_dwordx4 v[52:55], v104, s[16:19], s34 offen nt
s_addk_i32 s34, 8192
buffer_load_dwordx4 v[56:59], v104, s[16:19], s34 offen nt
s_addk_i32 s34, 8192
buffer_load_dwordx4 v[60:63], v104, s[16:19], s34 offen nt
s_barrier
v_mov_b32 v0, 0
v_lshrrev_b32 v102, 4, v1
v_and_b32 v103, 15, v1
s_lshl_b32 s98, s6, 3
s_add_u32 s98, s98, s7
s_and_b32 s9, s5, 3
s_mul_i32 s99, s4, 3
s_add_u32 s99, s99, s9
s_add_u32 s10, s4, 24
s_cmp_eq_u32 s9, 3
s_cselect_b32 s99, s10, s99
s_lshl_b32 s41, s4, 14
s_and_b32 s9, s98, 31
s_lshl_b32 s9, s9, 8
s_add_u32 s41, s41, s9
s_add_u32 s41, s41, 917504
s_and_b32 s43, s7, 3
s_lshl_b32 s43, s43, 1
s_lshr_b32 s9, s7, 2
s_add_u32 s43, s43, s9
s_lshl_b32 s43, s43, 13
s_mov_b32 s46, s43
s_lshl_b32 s9, s99, 6
s_add_u32 s43, s43, s9
s_add_u32 s43, s43, 851968
s_getreg_b32 s100, hwreg(HW_REG_XCC_ID, 0, 4)
s_cmp_lg_u32 s3, 3
s_cbranch_scc1 L_norst
v_mov_b32 v16, -1
v_mov_b32 v17, -1
v_mov_b32 v18, -1
v_mov_b32 v19, -1
v_lshlrev_b32 v110, 4, v103
v_lshrrev_b32 v111, 2, v103
v_lshlrev_b32 v111, 11, v111
v_and_b32 v109, 3, v1
v_lshl_add_u32 v111, v109, 4, v111
s_cmp_lt_u32 s99, 22
s_cselect_b32 s9, s43, 1073741824
v_add_u32 v108, s41, v110
v_add_u32 v109, s9, v111
v_cmp_gt_u32 vcc, 16, v1
s_nop 1
v_cndmask_b32 v108, v109, v108, vcc
s_add_u32 s9, s41, 0x2000
v_add_u32 v109, s9, v110
v_cmp_gt_u32 vcc, 32, v1
s_nop 1
v_cndmask_b32 v108, v109, v108, vcc
s_mov_b32 exec_lo, 0xffffffff
s_mov_b32 exec_hi, 0xffff
buffer_store_dwordx4 v[16:19], v108, s[20:23], 0 offen sc1
s_mov_b64 exec, -1
L_norst:
v_and_b32 v8, 1, v1
v_lshlrev_b32 v8, 4, v8
v_mov_b32 v9, 0xffff
v_lshlrev_b32 v8, v8, v9
v_bfe_u32 v9, v1, 1, 2
v_cmp_eq_u32 vcc, 0, v9
s_nop 1
v_cndmask_b32 v4, 0, v8, vcc
v_cmp_eq_u32 vcc, 1, v9
s_nop 1
v_cndmask_b32 v5, 0, v8, vcc
v_cmp_eq_u32 vcc, 2, v9
s_nop 1
v_cndmask_b32 v6, 0, v8, vcc
v_cmp_eq_u32 vcc, 3, v9
s_nop 1
v_cndmask_b32 v7, 0, v8, vcc
v_and_b32 v9, 16, v1
v_lshl_add_u32 v9, v3, 1, v9
v_and_b32 v10, 32, v1
v_lshl_add_u32 v9, v10, 3, v9
s_lshl_b32 s9, s3, 9
v_add_u32 v9, s9, v9
v_and_b32 v10, 4, v1
v_lshlrev_b32 v10, 12, v10
v_and_b32 v108, 2, v1
v_lshl_add_u32 v10, v108, 8, v10
v_lshl_add_u32 v10, v2, 5, v10
v_and_b32 v108, 1, v1
v_lshl_add_u32 v10, v108, 4, v10
s_waitcnt lgkmcnt(0)
s_add_u32 s8, s8, 0x9e3779b9
s_cmp_lg_u32 s3, 1
s_cbranch_scc1 L_not
v_mov_b32 v108, s100
v_mov_b32 v109, s8
s_lshl_b32 s35, s6, 7
s_add_u32 s35, s35, 8192
s_lshl_b32 s9, s7, 3
s_add_u32 s9, s9, s35
s_mov_b64 exec, 1
buffer_store_dwordx2 v[108:109], v0, s[20:23], s9 offen sc1
s_cmp_ge_u32 s2, 8
s_cbranch_scc1 L_not2
ds_read_b32 v110, v0 offset:512
v_mov_b32 v111, s8
s_waitcnt lgkmcnt(0)
s_lshl_b32 s9, s2, 7
s_add_u32 s9, s9, 1048576
s_add_u32 s10, s9, 0x2000
s_mov_b32 s93, s8
s_load_dword s92, s[90:91], s9
s_load_dword s93, s[90:91], s10
s_waitcnt lgkmcnt(1)
s_cmp_eq_u32 s93, s8
s_cselect_b32 s9, 1, 0
v_and_b32 v110, -2, v110
v_or_b32 v110, s9, v110
s_waitcnt lgkmcnt(0)
s_lshl_b32 s9, s2, 3
buffer_store_dwordx2 v[110:111], v0, s[20:23], s9 offen offset:2048 sc1
L_not2:
s_mov_b64 exec, -1
L_not:
s_cmp_ge_u32 s95, 192
s_cbranch_scc1 L_nomod
s_bitcmp1_b32 s3, 0
s_cbranch_scc1 L_wb1
s_waitcnt vmcnt(10)
L_wb1:
s_waitcnt vmcnt(11)
v_lshlrev_b32 v108, 16, v84
v_and_b32 v109, s11, v84
v_lshlrev_b32 v110, 16, v85
v_and_b32 v111, s11, v85
v_mul_f32 v112, 0xbfb8aa3b, v108
v_mul_f32 v113, 0xbfb8aa3b, v109
v_mul_f32 v114, 0xbfb8aa3b, v110
v_mul_f32 v115, 0xbfb8aa3b, v111
v_exp_f32 v112, v112
v_exp_f32 v113, v113
v_exp_f32 v114, v114
v_exp_f32 v115, v115
v_add_f32 v112, 1.0, v112
v_add_f32 v113, 1.0, v113
v_add_f32 v114, 1.0, v114
v_add_f32 v115, 1.0, v115
v_min_f32 v112, 0x7e800000, v112
v_min_f32 v113, 0x7e800000, v113
v_min_f32 v114, 0x7e800000, v114
v_min_f32 v115, 0x7e800000, v115
v_rcp_f32 v116, v112
v_rcp_f32 v117, v113
v_rcp_f32 v118, v114
v_rcp_f32 v119, v115
v_mul_f32 v120, v108, v116
v_mul_f32 v121, v109, v117
v_mul_f32 v122, v110, v118
v_mul_f32 v123, v111, v119
v_fma_f32 v112, -v120, v112, v108
v_fma_f32 v113, -v121, v113, v109
v_fma_f32 v114, -v122, v114, v110
v_fma_f32 v115, -v123, v115, v111
v_fma_f32 v112, v112, v116, v120
v_fma_f32 v113, v113, v117, v121
v_fma_f32 v114, v114, v118, v122
v_fma_f32 v115, v115, v119, v123
v_cvt_pk_bf16_f32 v112, v112, v112
v_cvt_pk_bf16_f32 v113, v113, v113
v_cvt_pk_bf16_f32 v114, v114, v114
v_cvt_pk_bf16_f32 v115, v115, v115
s_bitcmp1_b32 s3, 0
s_cbranch_scc1 L_wb2
s_waitcnt vmcnt(6)
L_wb2:
s_waitcnt vmcnt(7)
v_and_b32 v16, v112, v4
v_and_b32 v17, v112, v5
v_and_b32 v18, v112, v6
v_and_b32 v19, v112, v7
v_and_b32 v20, v113, v4
v_and_b32 v21, v113, v5
v_mfma_f32_16x16x32_bf16 v[12:15], v[16:19], v[32:35], 0
v_and_b32 v22, v113, v6
v_and_b32 v23, v113, v7
v_and_b32 v24, v114, v4
v_and_b32 v25, v114, v5
v_mfma_f32_16x16x32_bf16 v[12:15], v[20:23], v[36:39], v[12:15]
v_and_b32 v26, v114, v6
v_and_b32 v27, v114, v7
v_and_b32 v28, v115, v4
v_and_b32 v29, v115, v5
v_mfma_f32_16x16x32_bf16 v[12:15], v[24:27], v[40:43], v[12:15]
v_and_b32 v30, v115, v6
v_and_b32 v31, v115, v7
s_nop 1
v_mfma_f32_16x16x32_bf16 v[12:15], v[28:31], v[44:47], v[12:15]
s_mov_b32 exec_lo, 0xff00ff
s_mov_b32 exec_hi, 0xff00ff00
s_nop 5
ds_write_b128 v9, v[12:15] offset:1024
s_mov_b64 exec, -1
v_mov_b32 v108, 1
s_mov_b64 exec, 1
ds_add_u32 v0, v108 offset:0
s_mov_b64 exec, -1
s_cmp_lg_u32 s3, 0
s_cbranch_scc1 L_nomod
s_mov_b32 s10, 1048576
L_lw3:
ds_read_b32 v108, v0 offset:0
s_waitcnt lgkmcnt(0)
v_readfirstlane_b32 s9, v108
s_cmp_ge_u32 s9, 4
s_cbranch_scc1 L_lwd4
s_sub_u32 s10, s10, 1
s_cbranch_scc0 L_lw3
L_lwd4:
v_lshlrev_b32 v108, 3, v1
ds_read_b64 v[16:17], v108 offset:1024
ds_read_b64 v[18:19], v108 offset:1280
ds_read_b64 v[20:21], v108 offset:1536
ds_read_b64 v[22:23], v108 offset:1792
ds_read_b64 v[24:25], v108 offset:2048
ds_read_b64 v[26:27], v108 offset:2304
ds_read_b64 v[28:29], v108 offset:2560
ds_read_b64 v[30:31], v108 offset:2816
v_mov_b32 v113, s8
v_mov_b32 v115, s8
s_lshl_b32 s9, s95, 9
s_add_u32 s9, s9, 131072
s_waitcnt lgkmcnt(0)
v_pk_add_f32 v[16:17], v[16:17], v[24:25]
v_pk_add_f32 v[18:19], v[18:19], v[26:27]
v_pk_add_f32 v[20:21], v[20:21], v[28:29]
v_pk_add_f32 v[22:23], v[22:23], v[30:31]
v_pk_add_f32 v[16:17], v[16:17], v[20:21]
v_pk_add_f32 v[18:19], v[18:19], v[22:23]
v_add_f32 v112, v16, v18
v_add_f32 v114, v17, v19
s_mov_b32 exec_lo, 0xffffffff
s_mov_b32 exec_hi, 0x0
buffer_store_dwordx4 v[112:115], v11, s[20:23], s9 offen sc1
s_mov_b64 exec, -1
L_nomod:
s_waitcnt vmcnt(4)
v_mov_b32 v110, 0x3f803f80
v_dot2_f32_bf16 v108, v88, v110, 0
v_dot2_f32_bf16 v109, v88, v88, 0
v_dot2_f32_bf16 v108, v89, v110, v108
v_dot2_f32_bf16 v109, v89, v89, v109
v_dot2_f32_bf16 v108, v90, v110, v108
v_dot2_f32_bf16 v109, v90, v90, v109
v_dot2_f32_bf16 v108, v91, v110, v108
v_dot2_f32_bf16 v109, v91, v91, v109
s_nop 2
v_permlane32_swap_b32 v108, v109
v_add_f32 v108, v108, v109
v_mov_b32 v110, v108
s_nop 1
v_permlane16_swap_b32 v108, v110
v_add_f32 v108, v108, v110
s_nop 1
v_add_f32_dpp v108, v108, v108 row_ror:8 row_mask:0xf bank_mask:0xf
s_nop 1
v_add_f32_dpp v108, v108, v108 row_ror:4 row_mask:0xf bank_mask:0xf
s_nop 1
v_add_f32_dpp v108, v108, v108 row_ror:2 row_mask:0xf bank_mask:0xf
s_nop 1
v_add_f32_dpp v108, v108, v108 row_ror:1 row_mask:0xf bank_mask:0xf
v_mul_f32 v108, 0x3b000000, v108
v_mov_b32 v109, v108
s_nop 1
v_permlane32_swap_b32 v108, v109
v_fma_f32 v109, -v108, v108, v109
v_max_f32 v109, 0, v109
v_cvt_pk_bf16_f32 v108, 0, v108
v_cvt_pk_bf16_f32 v109, 0, v109
v_add_f32 v109, 0x3727c5ac, v109
v_cvt_pk_bf16_f32 v109, 0, v109
v_sqrt_f32 v109, v109
s_nop 0
v_cvt_pk_bf16_f32 v109, 0, v109
v_rcp_f32 v109, v109
v_lshlrev_b32 v92, 16, v92
v_sub_f32 v92, v92, v108
v_cvt_pk_bf16_f32 v92, 0, v92
v_mul_f32 v92, v92, v109
v_cvt_pk_bf16_f32 v92, 0, v92
s_lshr_b32 s101, s97, 1
s_lshl_b32 s101, s101, 11
s_and_b32 s9, s3, 1
s_lshl_b32 s9, s9, 8
s_add_u32 s101, s101, s9
s_add_u32 s101, s101, 131072
s_mov_b32 s10, 1048576
L_lw5:
ds_read_b32 v108, v0 offset:44
s_waitcnt lgkmcnt(0)
v_readfirstlane_b32 s9, v108
s_cmp_ge_u32 s9, 10
s_cbranch_scc1 L_lwd6
s_sleep 2
s_sub_u32 s10, s10, 1
s_cbranch_scc0 L_lw5
L_lwd6:
s_cmp_gt_u32 s3, 1
s_cbranch_scc1 L_p2b
v_lshrrev_b32 v101, 1, v3
s_cmp_eq_u32 s3, 0
s_cselect_b32 s35, 2048, s35
s_mov_b32 s10, 65536
L_pl7:
buffer_load_dwordx4 v[84:87], v10, s[20:23], s101 offen sc1
buffer_load_dwordx4 v[88:91], v10, s[20:23], s101 offen offset:1024 sc1
buffer_load_dwordx2 v[94:95], v101, s[20:23], s35 offen sc1
s_waitcnt vmcnt(0)
v_xor_b32 v108, s8, v85
v_xor_b32 v109, s8, v87
v_or_b32 v108, v108, v109
v_xor_b32 v109, s8, v89
v_or_b32 v108, v108, v109
v_xor_b32 v109, s8, v91
v_or_b32 v108, v108, v109
v_xor_b32 v109, s8, v95
v_or_b32 v108, v108, v109
v_cmp_ne_u32 vcc, 0, v108
s_cbranch_vccz L_pd8
s_sleep 4
s_sub_u32 s10, s10, 1
s_cbranch_scc0 L_pl7
L_pd8:
v_cmp_ne_u32 vcc, s100, v94
s_cmp_eq_u64 vcc, 0
s_cselect_b32 s94, 2, 1
v_and_b32 v108, 1, v94
v_cmp_ne_u32 vcc, 0, v108
s_and_b32 s9, vcc_lo, 15
s_bcnt1_i32_b32 s9, s9
s_and_b32 s10, vcc_lo, 0xf0
s_bcnt1_i32_b32 s10, s10
s_cmp_lt_u32 s9, s10
s_cselect_b32 s9, 4, 0
s_cmp_eq_u32 s3, 0
s_cselect_b32 s10, 52, 56
v_mov_b32 v108, s9
v_mov_b32 v109, s10
ds_write_b32 v109, v108
v_readfirstlane_b32 s9, v94
s_nop 1
v_subrev_u32 v94, s9, v94
s_nop 1
v_add_u32_dpp v94, v94, v94 quad_perm:[1,0,3,2] row_mask:0xf bank_mask:0xf
s_nop 1
v_add_u32_dpp v94, v94, v94 quad_perm:[2,3,0,1] row_mask:0xf bank_mask:0xf
s_nop 1
v_add_u32_dpp v94, v94, v94 row_half_mirror row_mask:0xf bank_mask:0xf
v_ashrrev_i32 v94, 3, v94
v_add_u32 v94, s9, v94
s_cmp_eq_u32 s3, 0
s_cselect_b32 s9, 40, 24
v_mov_b32 v109, s9
s_cbranch_scc1 L_p2d
v_mov_b32 v94, s94
L_p2d:
ds_write_b32 v109, v94
s_branch L_p2c
L_p2b:
s_mov_b32 s10, 65536
L_pl9:
buffer_load_dwordx4 v[84:87], v10, s[20:23], s101 offen sc1
buffer_load_dwordx4 v[88:91], v10, s[20:23], s101 offen offset:1024 sc1
s_waitcnt vmcnt(0)
v_xor_b32 v108, s8, v85
v_xor_b32 v109, s8, v87
v_or_b32 v108, v108, v109
v_xor_b32 v109, s8, v89
v_or_b32 v108, v108, v109
v_xor_b32 v109, s8, v91
v_or_b32 v108, v108, v109
v_cmp_ne_u32 vcc, 0, v108
s_cbranch_vccz L_pd10
s_sleep 4
s_sub_u32 s10, s10, 1
s_cbranch_scc0 L_pl9
L_pd10:
L_p2c:
v_add_f32 v84, v84, v88
v_add_f32 v86, v86, v90
s_nop 0
v_add_f32_dpp v84, v84, v84 quad_perm:[2,3,0,1] row_mask:0xf bank_mask:0xf
v_add_f32_dpp v86, v86, v86 quad_perm:[2,3,0,1] row_mask:0xf bank_mask:0xf
s_nop 0
v_mov_b32_dpp v88, v84 quad_perm:[0,0,1,1] row_mask:0xf bank_mask:0xf
v_mov_b32_dpp v90, v86 quad_perm:[0,0,1,1] row_mask:0xf bank_mask:0xf
s_mov_b32 s92, 0xaaaaaaaa
s_mov_b32 s93, 0xaaaaaaaa
v_cndmask_b32 v84, v88, v90, s[92:93]
v_cvt_pk_bf16_f32 v84, 0, v84
v_mov_b32 v72, v84
v_mov_b32 v76, v84
s_nop 0
v_mov_b32_dpp v72, v84 row_shr:4 row_mask:0xf bank_mask:0xa
v_mov_b32_dpp v76, v84 row_shl:4 row_mask:0xf bank_mask:0x5
v_add_f32 v76, 1.0, v76
v_cvt_pk_bf16_f32 v76, 0, v76
v_mul_f32 v92, v92, v76
v_cvt_pk_bf16_f32 v92, 0, v92
v_add_f32 v92, v92, v72
v_cvt_pk_bf16_f32 v92, v92, v92
s_nop 1
v_and_b32_dpp v16, v92, v4 quad_perm:[0,0,0,0] row_mask:0xf bank_mask:0xf
v_and_b32_dpp v17, v92, v5 quad_perm:[0,0,0,0] row_mask:0xf bank_mask:0xf
v_and_b32_dpp v18, v92, v6 quad_perm:[0,0,0,0] row_mask:0xf bank_mask:0xf
v_and_b32_dpp v19, v92, v7 quad_perm:[0,0,0,0] row_mask:0xf bank_mask:0xf
v_and_b32_dpp v20, v92, v4 quad_perm:[1,1,1,1] row_mask:0xf bank_mask:0xf
v_and_b32_dpp v21, v92, v5 quad_perm:[1,1,1,1] row_mask:0xf bank_mask:0xf
v_mfma_f32_16x16x32_bf16 v[12:15], v[16:19], v[48:51], 0
v_and_b32_dpp v22, v92, v6 quad_perm:[1,1,1,1] row_mask:0xf bank_mask:0xf
v_and_b32_dpp v23, v92, v7 quad_perm:[1,1,1,1] row_mask:0xf bank_mask:0xf
v_and_b32_dpp v24, v92, v4 quad_perm:[2,2,2,2] row_mask:0xf bank_mask:0xf
v_and_b32_dpp v25, v92, v5 quad_perm:[2,2,2,2] row_mask:0xf bank_mask:0xf
v_mfma_f32_16x16x32_bf16 v[12:15], v[20:23], v[52:55], v[12:15]
v_and_b32_dpp v26, v92, v6 quad_perm:[2,2,2,2] row_mask:0xf bank_mask:0xf
v_and_b32_dpp v27, v92, v7 quad_perm:[2,2,2,2] row_mask:0xf bank_mask:0xf
v_and_b32_dpp v28, v92, v4 quad_perm:[3,3,3,3] row_mask:0xf bank_mask:0xf
v_and_b32_dpp v29, v92, v5 quad_perm:[3,3,3,3] row_mask:0xf bank_mask:0xf
v_mfma_f32_16x16x32_bf16 v[12:15], v[24:27], v[56:59], v[12:15]
v_and_b32_dpp v30, v92, v6 quad_perm:[3,3,3,3] row_mask:0xf bank_mask:0xf
v_and_b32_dpp v31, v92, v7 quad_perm:[3,3,3,3] row_mask:0xf bank_mask:0xf
s_nop 1
v_mfma_f32_16x16x32_bf16 v[12:15], v[28:31], v[60:63], v[12:15]
s_mov_b32 exec_lo, 0xff00ff
s_mov_b32 exec_hi, 0xff00ff00
s_nop 5
ds_write_b128 v9, v[12:15] offset:3072
s_mov_b64 exec, -1
v_mov_b32 v108, 1
s_mov_b64 exec, 1
ds_add_u32 v0, v108 offset:4
s_mov_b64 exec, -1
s_cmp_lg_u32 s3, 1
s_cbranch_scc1 L_noqp
s_mov_b32 s10, 1048576
L_lw11:
ds_read_b32 v108, v0 offset:4
s_waitcnt lgkmcnt(0)
v_readfirstlane_b32 s9, v108
s_cmp_ge_u32 s9, 4
s_cbranch_scc1 L_lwd12
s_sub_u32 s10, s10, 1
s_cbranch_scc0 L_lw11
L_lwd12:
v_lshlrev_b32 v108, 3, v1
ds_read_b64 v[16:17], v108 offset:3072
ds_read_b64 v[18:19], v108 offset:3328
ds_read_b64 v[20:21], v108 offset:3584
ds_read_b64 v[22:23], v108 offset:3840
ds_read_b64 v[24:25], v108 offset:4096
ds_read_b64 v[26:27], v108 offset:4352
ds_read_b64 v[28:29], v108 offset:4608
ds_read_b64 v[30:31], v108 offset:4864
v_mov_b32 v113, s8
v_mov_b32 v115, s8
s_lshl_b32 s9, s98, 9
s_add_u32 s9, s9, 262144
s_waitcnt lgkmcnt(0)
v_pk_add_f32 v[16:17], v[16:17], v[24:25]
v_pk_add_f32 v[18:19], v[18:19], v[26:27]
v_pk_add_f32 v[20:21], v[20:21], v[28:29]
v_pk_add_f32 v[22:23], v[22:23], v[30:31]
v_pk_add_f32 v[16:17], v[16:17], v[20:21]
v_pk_add_f32 v[18:19], v[18:19], v[22:23]
v_add_f32 v112, v16, v18
v_add_f32 v114, v17, v19
s_mov_b32 exec_lo, 0xffffffff
s_mov_b32 exec_hi, 0x0
s_cmp_eq_u32 s94, 2
s_cbranch_scc0 L_sg13
buffer_store_dwordx4 v[112:115], v11, s[20:23], s9 offen
L_sd14:
s_mov_b64 exec, -1
L_noqp:
v_lshlrev_b32 v100, 10, v102
v_lshl_add_u32 v100, v103, 4, v100
s_lshl_b32 s101, s6, 12
s_lshl_b32 s9, s3, 8
s_add_u32 s101, s101, s9
s_add_u32 s101, s101, 262144
v_lshrrev_b32 v101, 5, v1
v_lshlrev_b32 v101, 1, v101
v_lshl_add_u32 v101, v103, 2, v101
s_lshl_b32 s9, s3, 6
v_add_u32 v101, s9, v101
s_sleep 24
s_mov_b32 s10, 65536
s_mov_b64 vcc, -1
L_tp15:
s_mov_b64 exec, vcc
buffer_load_dwordx4 v[84:87], v100, s[20:23], s101 offen sc1
s_mov_b64 exec, -1
s_sub_u32 s10, s10, 1
s_cbranch_scc1 L_td16
s_waitcnt vmcnt(0)
v_xor_b32 v108, s8, v85
v_xor_b32 v109, s8, v87
v_or_b32 v108, v108, v109
v_cmp_ne_u32 vcc, 0, v108
s_cbranch_vccnz L_tp15
L_td16:
v_permlane32_swap_b32 v84, v86
v_add_f32 v84, v84, v86
v_mov_b32 v86, v84
s_nop 1
v_permlane16_swap_b32 v84, v86
v_add_f32 v84, v84, v86
v_cvt_pk_bf16_f32 v84, v84, v84
ds_write_b16 v101, v84 offset:256
v_mov_b32 v108, 1
s_mov_b64 exec, 1
ds_add_u32 v0, v108 offset:8
s_mov_b64 exec, -1
s_mov_b32 s10, 1048576
L_lw17:
ds_read_b32 v108, v0 offset:24
s_waitcnt lgkmcnt(0)
v_readfirstlane_b32 s9, v108
s_cmp_ge_u32 s9, 1
s_cbranch_scc1 L_lwd18
s_sleep 1
s_sub_u32 s10, s10, 1
s_cbranch_scc0 L_lw17
L_lwd18:
s_mov_b32 s94, s9
s_mul_i32 s42, s6, 6144
s_add_u32 s42, s42, 524288
s_lshl_b32 s9, s7, 2
s_add_u32 s9, s9, s3
s_cmp_lg_u32 s9, 1
s_cbranch_scc1 L_nohr
s_mov_b32 s10, 1048576
L_lw19:
ds_read_b32 v108, v0 offset:8
s_waitcnt lgkmcnt(0)
v_readfirstlane_b32 s9, v108
s_cmp_ge_u32 s9, 4
s_cbranch_scc1 L_lwd20
s_sleep 2
s_sub_u32 s10, s10, 1
s_cbranch_scc0 L_lw19
L_lwd20:
s_lshl_b32 s9, s94, 8
s_or_b32 s9, s9, s100
v_mov_b32 v108, s9
v_mov_b32 v109, s8
s_lshl_b32 s9, s6, 3
s_add_u32 s9, s9, 4096
s_mov_b64 exec, 1
buffer_store_dwordx2 v[108:109], v0, s[20:23], s9 offen sc1
s_mov_b64 exec, -1
L_nohr:
s_cmp_lg_u32 s3, 2
s_cbranch_scc1 L_noog
v_mov_b32 v16, -1
v_mov_b32 v17, -1
v_mov_b32 v18, -1
v_mov_b32 v19, -1
s_lshl_b32 s9, s7, 9
v_add_u32 v108, s9, v11
v_lshrrev_b32 v109, 2, v103
v_lshlrev_b32 v109, 9, v109
v_and_b32 v110, 3, v1
v_lshl_add_u32 v109, v110, 4, v109
s_lshl_b32 s9, s7, 6
s_add_u32 s9, s9, 4096
v_add_u32 v109, s9, v109
v_cmp_gt_u32 vcc, 32, v1
s_nop 1
v_cndmask_b32 v108, v109, v108, vcc
s_mov_b32 exec_lo, 0xffffffff
s_mov_b32 exec_hi, 0xffff
s_cmp_eq_u32 s94, 2
s_cbranch_scc0 L_sg21
buffer_store_dwordx4 v[16:19], v108, s[20:23], s42 offen
L_sd22:
s_mov_b64 exec, -1
L_noog:
s_mov_b32 s16, s46
s_mov_b64 s[24:25], s[72:73]
s_mov_b32 s26, 0x400000
s_mov_b32 s27, 0x20000
s_mov_b64 s[32:33], s[80:81]
s_mov_b32 s34, 0x158000
s_mov_b32 s35, 0x20000
s_mov_b64 s[44:45], s[86:87]
s_mov_b32 s46, 0x400
s_mov_b32 s47, 0x20000
s_cmp_ge_u32 s7, 4
s_cselect_b32 s28, s78, s76
s_cselect_b32 s29, s79, s77
s_mov_b32 s30, 1409024
s_mov_b32 s31, 0x20000
s_and_b32 s96, s7, 3
s_lshl_b32 s96, s96, 2
s_add_u32 s96, s96, s3
s_cmp_ge_u32 s99, 22
s_cbranch_scc1 L_nosb
s_lshr_b32 s101, s96, 1
s_lshl_b32 s101, s101, 11
s_and_b32 s9, s3, 1
s_lshl_b32 s9, s9, 8
s_add_u32 s101, s101, s9
s_add_u32 s101, s101, 180224
s_mov_b32 s10, 65536
L_pl23:
buffer_load_dwordx4 v[84:87], v10, s[20:23], s101 offen sc1
buffer_load_dwordx4 v[88:91], v10, s[20:23], s101 offen offset:1024 sc1
s_waitcnt vmcnt(0)
v_xor_b32 v108, s8, v85
v_xor_b32 v109, s8, v87
v_or_b32 v108, v108, v109
v_xor_b32 v109, s8, v89
v_or_b32 v108, v108, v109
v_xor_b32 v109, s8, v91
v_or_b32 v108, v108, v109
v_cmp_ne_u32 vcc, 0, v108
s_cbranch_vccz L_pd24
s_sleep 4
s_sub_u32 s10, s10, 1
s_cbranch_scc0 L_pl23
L_pd24:
v_add_f32 v84, v84, v88
v_add_f32 v86, v86, v90
s_nop 0
v_add_f32_dpp v84, v84, v84 quad_perm:[2,3,0,1] row_mask:0xf bank_mask:0xf
v_add_f32_dpp v86, v86, v86 quad_perm:[2,3,0,1] row_mask:0xf bank_mask:0xf
s_nop 0
v_mov_b32_dpp v88, v84 quad_perm:[0,0,1,1] row_mask:0xf bank_mask:0xf
v_mov_b32_dpp v90, v86 quad_perm:[0,0,1,1] row_mask:0xf bank_mask:0xf
s_mov_b32 s92, 0xaaaaaaaa
s_mov_b32 s93, 0xaaaaaaaa
v_cndmask_b32 v84, v88, v90, s[92:93]
v_cvt_pk_bf16_f32 v84, 0, v84
v_mov_b32 v72, v84
v_mov_b32 v76, v84
s_nop 0
v_mov_b32_dpp v72, v84 row_shr:4 row_mask:0xf bank_mask:0xa
v_mov_b32_dpp v76, v84 row_shl:4 row_mask:0xf bank_mask:0x5
v_add_f32 v76, 1.0, v76
v_cvt_pk_bf16_f32 v76, 0, v76
L_nosb:
v_lshlrev_b32 v116, 5, v3
v_lshl_add_u32 v116, v2, 4, v116
v_lshlrev_b32 v121, 2, v3
v_lshl_add_u32 v121, v2, 3, v121
v_lshlrev_b32 v114, 9, v102
v_lshl_add_u32 v114, v103, 2, v114
v_lshrrev_b32 v117, 2, v1
v_lshlrev_b32 v117, 11, v117
v_and_b32 v101, 3, v1
v_lshl_add_u32 v117, v101, 4, v117
v_lshlrev_b32 v113, 14, v102
v_and_b32 v117, 0x1fff, v117
v_add_u32 v117, v117, v113
v_mov_b32 v118, 1073741824
v_cmp_gt_u32 vcc, 24, v1
s_nop 1
v_cndmask_b32 v118, v118, v11, vcc
v_lshlrev_b32 v115, 11, v102
v_lshl_add_u32 v115, v103, 2, v115
v_lshl_add_u32 v119, v101, 2, v102
v_lshlrev_b32 v119, 2, v119
v_lshlrev_b32 v120, 5, v2
v_lshl_add_u32 v120, v101, 3, v120
v_and_b32 v122, 3, v2
v_lshlrev_b32 v122, 4, v122
v_lshrrev_b32 v127, 2, v2
v_add_u32 v122, v122, v127
v_lshl_add_u32 v122, v122, 10, v3
v_lshlrev_b32 v127, 2, v1
v_lshlrev_b32 v74, 3, v1
v_mov_b32 v83, 1
v_mul_u32_u24 v123, 11008, v2
v_add_u32 v123, v123, v3
s_cmp_eq_u32 s99, 21
s_cselect_b32 s9, 64, 128
v_mov_b32 v101, 1073741824
v_cmp_gt_u32 vcc, s9, v3
s_nop 1
v_cndmask_b32 v123, v101, v123, vcc
v_lshl_add_u32 v124, v2, 13, v3
s_lshl_b32 s40, s7, 6
s_add_u32 s40, s40, s3
v_lshlrev_b32 v125, 3, v119
v_lshlrev_b32 v126, 1, v119
s_lshl_b32 s9, s40, 1
v_add_u32 v126, s9, v126
s_lshl_b32 s9, s40, 3
v_add_u32 v73, s9, v125
s_lshl_b32 s9, s7, 5
s_lshl_b32 s10, s3, 3
s_add_u32 s9, s9, s10
s_add_u32 s9, s9, 4096
v_lshrrev_b32 v77, 5, v1
v_lshl_add_u32 v77, v77, 8, s9
v_and_b32 v101, 4, v1
v_cmp_ne_u32 vcc, 0, v101
s_nop 1
v_cndmask_b32 v73, v73, v77, vcc
s_cmp_lt_u32 s99, 24
s_cbranch_scc1 L_noga
buffer_load_ushort v82, v126, s[36:39], 0 offen
L_noga:
s_lshl_b32 s14, s6, 7
s_add_u32 s14, s14, 16384
s_cmp_lg_u32 s3, 2
s_cbranch_scc1 L_mid
v_lshrrev_b32 v100, 1, v3
s_mov_b32 s10, 1048576
L_lw25:
ds_read_b32 v108, v0 offset:32
s_waitcnt lgkmcnt(0)
v_readfirstlane_b32 s9, v108
s_cmp_ge_u32 s9, 8
s_cbranch_scc1 L_lwd26
s_sleep 1
s_sub_u32 s10, s10, 1
s_cbranch_scc0 L_lw25
L_lwd26:
ds_read_b64 v[84:85], v100 offset:64
s_waitcnt lgkmcnt(0)
v_mov_b32 v88, v84
s_nop 1
v_max_f32_dpp v88, v88, v88 quad_perm:[1,0,3,2] row_mask:0xf bank_mask:0xf
s_nop 1
v_max_f32_dpp v88, v88, v88 quad_perm:[2,3,0,1] row_mask:0xf bank_mask:0xf
s_nop 1
v_max_f32_dpp v88, v88, v88 row_half_mirror row_mask:0xf bank_mask:0xf
ds_write_b32 v0, v88 offset:16
s_waitcnt vmcnt(0)
v_mov_b32 v108, 1
s_mov_b64 exec, 1
ds_add_u32 v0, v108 offset:12
s_mov_b64 exec, -1
v_sub_f32 v84, v84, v88
v_mul_f32 v84, 0x3fb8aa3b, v84
v_exp_f32 v84, v84
s_nop 0
v_mul_f32 v90, v84, v85
s_nop 1
v_add_f32_dpp v90, v90, v90 quad_perm:[1,0,3,2] row_mask:0xf bank_mask:0xf
s_nop 1
v_add_f32_dpp v90, v90, v90 quad_perm:[2,3,0,1] row_mask:0xf bank_mask:0xf
s_nop 1
v_add_f32_dpp v90, v90, v90 row_half_mirror row_mask:0xf bank_mask:0xf
v_mov_b32 v89, s8
v_mov_b32 v91, s8
s_lshl_b32 s9, s7, 4
s_add_u32 s9, s9, s14
s_waitcnt vmcnt(0)
s_mov_b64 exec, 1
s_cmp_eq_u32 s94, 2
s_cbranch_scc0 L_sg27
buffer_store_dwordx4 v[88:91], v0, s[20:23], s9 offen
L_sd28:
s_mov_b64 exec, -1
L_mid:
s_mul_i32 s19, s6, 6144
s_add_u32 s19, s19, 524288
s_lshl_b32 s9, s3, 7
s_add_u32 s12, s19, s9
s_lshl_b32 s9, s3, 9
s_add_u32 s19, s19, s9
s_add_u32 s19, s19, 4096
s_lshl_b32 s9, s7, 6
s_add_u32 s42, s42, s9
s_add_u32 s42, s42, 4096
s_lshl_b32 s9, s3, 6
s_lshl_b32 s13, s7, 8
s_add_u32 s13, s13, s9
s_lshl_b32 s10, s13, 5
s_lshl_b32 s10, s3, 11
s_add_u32 s10, s10, s16
s_add_u32 s16, s10, 851968
s_add_u32 s17, s16, 1024
s_add_u32 s13, s13, 917504
s_lshl_b32 s40, s4, 13
s_add_u32 s40, s40, 32768
s_lshl_b32 s18, s96, 8
s_add_u32 s18, s18, s40
s_add_u32 s15, s40, 4096
s_mul_i32 s36, s96, 88064
s_lshl_b32 s10, s99, 7
s_add_u32 s36, s36, s10
s_add_u32 s37, s36, 5504
s_lshl_b32 s38, s99, 16
s_lshl_b32 s10, s3, 10
s_add_u32 s38, s38, s10
s_lshl_b32 s10, s7, 7
s_add_u32 s38, s38, s10
s_add_u32 s39, s38, 4096
s_lshl_b32 s95, s6, 17
s_lshr_b32 s10, s3, 1
s_lshl_b32 s10, s10, 16
s_add_u32 s95, s95, s10
s_and_b32 s10, s3, 1
s_lshl_b32 s10, s10, 11
s_add_u32 s95, s95, s10
s_lshl_b32 s10, s7, 7
s_add_u32 s95, s95, s10
v_and_b32 v100, 31, v1
v_lshlrev_b32 v100, 3, v100
s_cmp_ge_u32 s99, 24
s_cselect_b32 s98, 4096, s14
s_cselect_b32 s9, -1, 0
v_and_b32 v100, s9, v100
s_add_u32 s101, s41, 0x2000
s_lshl_b32 s62, 0x01010101, s7
s_mov_b32 s63, s62
v_lshlrev_b32 v112, 4, v2
s_lshl_b32 s9, s3, 7
v_add_u32 v112, s9, v112
s_mov_b32 s10, 1048576
L_lw29:
ds_read_b32 v108, v0 offset:28
s_waitcnt lgkmcnt(0)
v_readfirstlane_b32 s9, v108
s_cmp_ge_u32 s9, 1
s_cbranch_scc1 L_lwd30
s_sleep 2
s_sub_u32 s10, s10, 1
s_cbranch_scc0 L_lw29
L_lwd30:
buffer_load_dwordx4 v[96:99], v3, s[20:23], s14 offen sc1
buffer_load_dwordx2 v[94:95], v100, s[20:23], s98 offen sc1
s_mov_b32 s10, 1048576
L_lw31:
ds_read_b32 v108, v0 offset:48
s_waitcnt lgkmcnt(0)
v_readfirstlane_b32 s9, v108
s_cmp_ge_u32 s9, 5
s_cbranch_scc1 L_lwd32
s_sleep 1
s_sub_u32 s10, s10, 1
s_cbranch_scc0 L_lw31
L_lwd32:
buffer_load_dwordx4 v[32:35], v122, s[24:27], s95 offen nt
s_addk_i32 s95, 4096
buffer_load_dwordx4 v[36:39], v122, s[24:27], s95 offen nt
s_addk_i32 s95, 4096
buffer_load_dwordx4 v[40:43], v122, s[24:27], s95 offen nt
s_addk_i32 s95, 4096
buffer_load_dwordx4 v[44:47], v122, s[24:27], s95 offen nt
s_waitcnt vmcnt(4)
v_xor_b32 v108, s8, v97
v_xor_b32 v109, s8, v99
v_or_b32 v108, v108, v109
v_xor_b32 v109, s8, v95
v_or_b32 v108, v108, v109
v_cmp_ne_u32 vcc, 0, v108
s_cbranch_vccz L_mlok
s_mov_b32 s10, 65536
L_pl33:
buffer_load_dwordx4 v[96:99], v3, s[20:23], s14 offen sc1
buffer_load_dwordx2 v[94:95], v100, s[20:23], s98 offen sc1
s_waitcnt vmcnt(0)
v_xor_b32 v108, s8, v97
v_xor_b32 v109, s8, v99
v_or_b32 v108, v108, v109
v_xor_b32 v109, s8, v95
v_or_b32 v108, v108, v109
v_cmp_ne_u32 vcc, 0, v108
s_cbranch_vccz L_pd34
s_sleep 1
s_sub_u32 s10, s10, 1
s_cbranch_scc0 L_pl33
L_pd34:
L_mlok:
v_mov_b32 v97, v96
s_nop 1
v_max_f32_dpp v97, v97, v97 quad_perm:[1,0,3,2] row_mask:0xf bank_mask:0xf
s_nop 1
v_max_f32_dpp v97, v97, v97 quad_perm:[2,3,0,1] row_mask:0xf bank_mask:0xf
s_nop 1
v_max_f32_dpp v97, v97, v97 row_half_mirror row_mask:0xf bank_mask:0xf
v_sub_f32 v96, v96, v97
v_mul_f32 v96, 0x3fb8aa3b, v96
v_exp_f32 v96, v96
s_nop 0
v_mul_f32 v97, v96, v98
s_nop 1
v_add_f32_dpp v97, v97, v97 quad_perm:[1,0,3,2] row_mask:0xf bank_mask:0xf
s_nop 1
v_add_f32_dpp v97, v97, v97 quad_perm:[2,3,0,1] row_mask:0xf bank_mask:0xf
s_nop 1
v_add_f32_dpp v97, v97, v97 row_half_mirror row_mask:0xf bank_mask:0xf
v_rcp_f32 v97, v97
s_nop 0
v_mul_f32 v98, v96, v97
v_mov_b32 v99, v98
s_or_b32 s9, s100, 0x200
v_cmp_ne_u32 vcc, s9, v94
s_lshl_b32 s9, s4, 2
s_lshr_b32 s9, vcc_lo, s9
s_and_b32 s9, s9, 15
s_cselect_b32 s100, 1, 2
s_mov_b32 s10, 1048576
L_lw35:
ds_read_b32 v108, v0 offset:140
s_waitcnt lgkmcnt(0)
v_readfirstlane_b32 s9, v108
s_cmp_ge_u32 s9, 8
s_cbranch_scc1 L_lwd36
s_sub_u32 s10, s10, 1
s_cbranch_scc0 L_lw35
L_lwd36:
s_andn2_b64 exec, -1, s[62:63]
buffer_load_dwordx4 v[128:131], v116, s[20:23], s12 offen sc1
s_mov_b64 exec, -1
s_mov_b32 s10, 1048576
L_lw37:
ds_read_b32 v108, v0 offset:140
s_waitcnt lgkmcnt(0)
v_readfirstlane_b32 s9, v108
s_cmp_ge_u32 s9, 16
s_cbranch_scc1 L_lwd38
s_sub_u32 s10, s10, 1
s_cbranch_scc0 L_lw37
L_lwd38:
s_mov_b64 exec, s[62:63]
ds_read_b128 v[128:131], v112 offset:3072
s_mov_b64 exec, -1
s_waitcnt vmcnt(0) lgkmcnt(0)
v_max3_u32 v108, v128, v129, v130
v_max_u32 v108, v108, v131
v_cmp_eq_u32 vcc, -1, v108
s_cbranch_vccz L_cok
s_mov_b32 s10, 65536
L_tp39:
s_mov_b64 exec, vcc
buffer_load_dwordx4 v[128:131], v116, s[20:23], s12 offen sc1
s_mov_b64 exec, -1
s_sub_u32 s10, s10, 1
s_cbranch_scc1 L_td40
s_waitcnt vmcnt(0)
v_max3_u32 v108, v128, v129, v130
v_max_u32 v108, v108, v131
v_cmp_eq_u32 vcc, -1, v108
s_cbranch_vccnz L_tp39
L_td40:
L_cok:
v_pk_mul_f32 v[84:85], v[128:129], v[98:99]
v_pk_mul_f32 v[86:87], v[130:131], v[98:99]
s_cmp_ge_u32 s99, 22
s_cbranch_scc1 L_ne
s_barrier
buffer_load_dwordx4 v[64:67], v124, s[32:35], s38 offen nt
buffer_load_dwordx4 v[68:71], v124, s[32:35], s39 offen nt
L_ne:
v_add_f32_dpp v84, v84, v84 quad_perm:[1,0,3,2] row_mask:0xf bank_mask:0xf
v_add_f32_dpp v85, v85, v85 quad_perm:[1,0,3,2] row_mask:0xf bank_mask:0xf
v_add_f32_dpp v86, v86, v86 quad_perm:[1,0,3,2] row_mask:0xf bank_mask:0xf
v_add_f32_dpp v87, v87, v87 quad_perm:[1,0,3,2] row_mask:0xf bank_mask:0xf
v_add_f32_dpp v84, v84, v84 quad_perm:[2,3,0,1] row_mask:0xf bank_mask:0xf
v_add_f32_dpp v85, v85, v85 quad_perm:[2,3,0,1] row_mask:0xf bank_mask:0xf
v_add_f32_dpp v86, v86, v86 quad_perm:[2,3,0,1] row_mask:0xf bank_mask:0xf
v_add_f32_dpp v87, v87, v87 quad_perm:[2,3,0,1] row_mask:0xf bank_mask:0xf
v_add_f32_dpp v84, v84, v84 row_half_mirror row_mask:0xf bank_mask:0xf
v_add_f32_dpp v85, v85, v85 row_half_mirror row_mask:0xf bank_mask:0xf
v_add_f32_dpp v86, v86, v86 row_half_mirror row_mask:0xf bank_mask:0xf
v_add_f32_dpp v87, v87, v87 row_half_mirror row_mask:0xf bank_mask:0xf
v_cvt_pk_bf16_f32 v84, v84, v84
v_cvt_pk_bf16_f32 v85, v85, v85
v_cvt_pk_bf16_f32 v86, v86, v86
v_cvt_pk_bf16_f32 v87, v87, v87
v_and_b32 v16, v84, v4
v_and_b32 v17, v84, v5
v_and_b32 v18, v84, v6
v_and_b32 v19, v84, v7
v_and_b32 v20, v85, v4
v_and_b32 v21, v85, v5
v_mfma_f32_16x16x32_bf16 v[12:15], v[16:19], v[32:35], 0
v_and_b32 v22, v85, v6
v_and_b32 v23, v85, v7
v_and_b32 v24, v86, v4
v_and_b32 v25, v86, v5
v_mfma_f32_16x16x32_bf16 v[12:15], v[20:23], v[36:39], v[12:15]
v_and_b32 v26, v86, v6
v_and_b32 v27, v86, v7
v_and_b32 v28, v87, v4
v_and_b32 v29, v87, v5
v_mfma_f32_16x16x32_bf16 v[12:15], v[24:27], v[40:43], v[12:15]
v_and_b32 v30, v87, v6
v_and_b32 v31, v87, v7
s_nop 1
v_mfma_f32_16x16x32_bf16 v[12:15], v[28:31], v[44:47], v[12:15]
s_mov_b32 exec_lo, 0xff00ff
s_mov_b32 exec_hi, 0xff00ff00
s_nop 5
ds_write_b128 v9, v[12:15] offset:9216
s_mov_b64 exec, 1
ds_add_rtn_u32 v93, v0, v83 offset:128
s_mov_b64 exec, -1
ds_read_b128 v[84:87], v11 offset:9216
ds_read_b128 v[88:91], v11 offset:10240
s_waitcnt lgkmcnt(2)
v_readfirstlane_b32 s9, v93
s_cmp_lg_u32 s9, 3
s_cbranch_scc1 L_pb41
s_waitcnt lgkmcnt(0)
v_pk_add_f32 v[84:85], v[84:85], v[88:89]
v_pk_add_f32 v[86:87], v[86:87], v[90:91]
s_nop 1
v_permlane32_swap_b32 v84, v86
v_permlane32_swap_b32 v85, v87
v_pk_add_f32 v[84:85], v[84:85], v[86:87]
s_nop 1
v_permlane16_swap_b32 v84, v85
v_add_f32 v84, v84, v85
buffer_store_dword v84, v127, s[20:23], s41 offen sc1
buffer_store_dword v84, v127, s[20:23], s101 offen sc1
L_pb41:
s_waitcnt lgkmcnt(0)
s_barrier
s_cmp_ge_u32 s99, 22
s_cbranch_scc1 L_red
buffer_load_dwordx4 v[48:51], v123, s[28:31], s36 offen offset:0 nt
buffer_load_dwordx4 v[52:55], v123, s[28:31], s36 offen offset:2752 nt
buffer_load_dwordx4 v[56:59], v123, s[28:31], s37 offen offset:0 nt
buffer_load_dwordx4 v[60:63], v123, s[28:31], s37 offen offset:2752 nt
s_lshl_b32 s9, s3, 9
s_add_u32 s9, s9, s42
s_mov_b64 exec, 1
buffer_load_dword v136, v0, s[20:23], s9 offen sc1
s_mov_b64 exec, -1
s_mov_b32 s10, 65536
s_mov_b64 vcc, -1
s_mov_b64 s[92:93], -1
L_tp42:
s_or_b64 exec, vcc, 1
buffer_load_dwordx2 v[132:133], v74, s[20:23], s15 offen sc1
s_or_b64 exec, s[92:93], 1
buffer_load_dwordx2 v[134:135], v120, s[20:23], s18 offen sc1
s_mov_b64 exec, -1
s_sub_u32 s10, s10, 1
s_cbranch_scc1 L_td43
s_waitcnt vmcnt(0)
v_cmp_ne_u32 vcc, s8, v133
v_cmp_ne_u32 s[92:93], s8, v135
s_or_b64 s[96:97], vcc, s[92:93]
s_cbranch_scc1 L_tp42
L_td43:
v_add_f32_dpp v108, v132, v132 row_ror:8 row_mask:0xf bank_mask:0xf
s_nop 1
v_add_f32_dpp v108, v108, v108 row_ror:4 row_mask:0xf bank_mask:0xf
s_nop 1
v_add_f32_dpp v108, v108, v108 row_ror:2 row_mask:0xf bank_mask:0xf
s_nop 1
v_add_f32_dpp v108, v108, v108 row_ror:1 row_mask:0xf bank_mask:0xf
v_mov_b32 v110, v108
s_nop 1
v_permlane16_swap_b32 v108, v110
v_add_f32 v108, v108, v110
v_mov_b32 v109, v108
s_nop 1
v_permlane32_swap_b32 v108, v109
v_fma_f32 v109, -v108, v108, v109
v_max_f32 v109, 0, v109
v_cvt_pk_bf16_f32 v109, 0, v109
v_add_f32 v109, 0x3727c5ac, v109
v_cvt_pk_bf16_f32 v109, 0, v109
v_sqrt_f32 v109, v109
v_cvt_pk_bf16_f32 v108, 0, v108
v_cvt_pk_bf16_f32 v109, 0, v109
v_rcp_f32 v109, v109
v_sub_f32 v92, v134, v108
v_cvt_pk_bf16_f32 v92, 0, v92
v_mul_f32 v92, v92, v109
v_cvt_pk_bf16_f32 v92, 0, v92
v_mul_f32 v92, v92, v76
v_cvt_pk_bf16_f32 v92, 0, v92
v_add_f32 v92, v92, v72
v_cvt_pk_bf16_f32 v92, v92, v92
s_nop 1
v_and_b32_dpp v16, v92, v4 quad_perm:[0,0,0,0] row_mask:0xf bank_mask:0xf
v_and_b32_dpp v17, v92, v5 quad_perm:[0,0,0,0] row_mask:0xf bank_mask:0xf
v_and_b32_dpp v18, v92, v6 quad_perm:[0,0,0,0] row_mask:0xf bank_mask:0xf
v_and_b32_dpp v19, v92, v7 quad_perm:[0,0,0,0] row_mask:0xf bank_mask:0xf
v_and_b32_dpp v20, v92, v4 quad_perm:[1,1,1,1] row_mask:0xf bank_mask:0xf
v_and_b32_dpp v21, v92, v5 quad_perm:[1,1,1,1] row_mask:0xf bank_mask:0xf
v_mfma_f32_16x16x32_bf16 v[12:15], v[16:19], v[48:51], 0
v_and_b32_dpp v22, v92, v6 quad_perm:[1,1,1,1] row_mask:0xf bank_mask:0xf
v_and_b32_dpp v23, v92, v7 quad_perm:[1,1,1,1] row_mask:0xf bank_mask:0xf
v_and_b32_dpp v24, v92, v4 quad_perm:[2,2,2,2] row_mask:0xf bank_mask:0xf
v_and_b32_dpp v25, v92, v5 quad_perm:[2,2,2,2] row_mask:0xf bank_mask:0xf
v_mfma_f32_16x16x32_bf16 v[12:15], v[20:23], v[52:55], v[12:15]
v_and_b32_dpp v26, v92, v6 quad_perm:[2,2,2,2] row_mask:0xf bank_mask:0xf
v_and_b32_dpp v27, v92, v7 quad_perm:[2,2,2,2] row_mask:0xf bank_mask:0xf
v_and_b32_dpp v28, v92, v4 quad_perm:[3,3,3,3] row_mask:0xf bank_mask:0xf
v_and_b32_dpp v29, v92, v5 quad_perm:[3,3,3,3] row_mask:0xf bank_mask:0xf
v_mfma_f32_16x16x32_bf16 v[12:15], v[24:27], v[56:59], v[12:15]
v_and_b32_dpp v30, v92, v6 quad_perm:[3,3,3,3] row_mask:0xf bank_mask:0xf
v_and_b32_dpp v31, v92, v7 quad_perm:[3,3,3,3] row_mask:0xf bank_mask:0xf
s_nop 1
v_mfma_f32_16x16x32_bf16 v[12:15], v[28:31], v[60:63], v[12:15]
s_mov_b32 exec_lo, 0xff00ff
s_mov_b32 exec_hi, 0xff00ff00
s_nop 5
ds_write_b128 v9, v[12:15] offset:11264
s_mov_b64 exec, 1
ds_add_rtn_u32 v93, v0, v83 offset:132
s_mov_b64 exec, -1
ds_read_b128 v[84:87], v11 offset:11264
ds_read_b128 v[88:91], v11 offset:12288
s_waitcnt lgkmcnt(2)
v_readfirstlane_b32 s9, v93
s_cmp_lg_u32 s9, 3
s_cbranch_scc1 L_pb44
s_cmp_eq_u32 s94, 2
s_waitcnt lgkmcnt(0)
v_pk_add_f32 v[84:85], v[84:85], v[88:89]
v_pk_add_f32 v[86:87], v[86:87], v[90:91]
s_nop 1
v_permlane32_swap_b32 v84, v86
v_permlane32_swap_b32 v85, v87
v_pk_add_f32 v[84:85], v[84:85], v[86:87]
s_nop 1
v_permlane16_swap_b32 v84, v85
v_add_f32 v84, v84, v85
s_cbranch_scc0 L_sg45
buffer_store_dword v84, v114, s[20:23], s42 offen
L_sd46:
L_pb44:
s_waitcnt lgkmcnt(0)
s_mov_b32 s10, 65536
s_mov_b64 vcc, -1
L_tp47:
s_mov_b64 exec, vcc
buffer_load_dwordx2 v[136:137], v121, s[20:23], s19 offen sc1
s_mov_b64 exec, -1
s_sub_u32 s10, s10, 1
s_cbranch_scc1 L_td48
s_waitcnt vmcnt(0)
v_max_u32 v108, v136, v137
v_cmp_eq_u32 vcc, -1, v108
s_cbranch_vccnz L_tp47
L_td48:
v_add_f32_dpp v88, v136, v136 quad_perm:[1,0,3,2] row_mask:0xf bank_mask:0xf
v_add_f32_dpp v89, v137, v137 quad_perm:[1,0,3,2] row_mask:0xf bank_mask:0xf
s_nop 0
v_add_f32_dpp v88, v88, v88 quad_perm:[2,3,0,1] row_mask:0xf bank_mask:0xf
v_add_f32_dpp v89, v89, v89 quad_perm:[2,3,0,1] row_mask:0xf bank_mask:0xf
v_cvt_pk_bf16_f32 v88, 0, v88
v_cvt_pk_bf16_f32 v89, 0, v89
s_nop 0
v_mul_f32_dpp v90, v88, v88 row_half_mirror row_mask:0xf bank_mask:0xf
v_mul_f32_dpp v91, v89, v89 row_half_mirror row_mask:0xf bank_mask:0xf
v_cvt_pk_bf16_f32 v90, v90, v90
v_cvt_pk_bf16_f32 v91, v91, v91
v_and_b32 v16, v90, v4
v_and_b32 v17, v90, v5
v_and_b32 v18, v90, v6
v_and_b32 v19, v90, v7
v_and_b32 v20, v91, v4
v_and_b32 v21, v91, v5
v_mfma_f32_16x16x32_bf16 v[12:15], v[16:19], v[64:67], 0
v_and_b32 v22, v91, v6
v_and_b32 v23, v91, v7
s_nop 1
v_mfma_f32_16x16x32_bf16 v[12:15], v[20:23], v[68:71], v[12:15]
s_mov_b32 exec_lo, 0xff00ff
s_mov_b32 exec_hi, 0xff00ff00
s_nop 5
ds_write_b128 v9, v[12:15] offset:13312
s_mov_b64 exec, 1
ds_add_rtn_u32 v93, v0, v83 offset:136
s_mov_b64 exec, -1
ds_read_b128 v[84:87], v11 offset:13312
ds_read_b128 v[88:91], v11 offset:14336
s_waitcnt lgkmcnt(2)
v_readfirstlane_b32 s9, v93
s_cmp_lg_u32 s9, 3
s_cbranch_scc1 L_pb49
s_waitcnt lgkmcnt(0)
v_pk_add_f32 v[84:85], v[84:85], v[88:89]
v_pk_add_f32 v[86:87], v[86:87], v[90:91]
s_nop 1
v_permlane32_swap_b32 v84, v86
v_permlane32_swap_b32 v85, v87
v_pk_add_f32 v[84:85], v[84:85], v[86:87]
s_nop 1
v_permlane16_swap_b32 v84, v85
v_add_f32 v84, v84, v85
buffer_store_dword v84, v115, s[20:23], s43 offen sc1
L_pb49:
s_waitcnt lgkmcnt(0)
s_add_u32 s9, s2, s3
s_cmp_lg_u32 s9, 0
s_cbranch_scc1 L_fin2
v_mov_b32 v79, s8
s_mov_b64 exec, 1
buffer_store_dword v79, v0, s[20:23], 0 offen sc1
s_branch L_fin2
L_red:
s_cmp_lt_u32 s99, 24
s_cbranch_scc1 L_fin2
ds_read_b32 v68, v0 offset:52
s_waitcnt lgkmcnt(0)
v_bfe_u32 v75, v1, 2, 2
v_lshl_add_u32 v75, v75, 9, v125
s_lshl_b32 s38, s7, 11
s_lshl_b32 s9, s3, 3
s_add_u32 s38, s38, s9
s_add_u32 s38, s38, 163840
s_add_u32 s39, s38, 49152
s_mov_b32 s10, 65536
L_pl50:
buffer_load_dwordx2 v[64:65], v75, s[20:23], s38 offen sc1
s_waitcnt vmcnt(0)
v_cmp_ne_u32 vcc, s8, v65
s_cbranch_vccz L_pd51
s_sleep 4
s_sub_u32 s10, s10, 1
s_cbranch_scc0 L_pl50
L_pd51:
v_add_f32_dpp v64, v64, v64 row_ror:4 row_mask:0xf bank_mask:0xf
s_nop 1
v_add_f32_dpp v64, v64, v64 row_ror:8 row_mask:0xf bank_mask:0xf
v_cvt_pk_bf16_f32 v64, 0, v64
v_lshlrev_b32 v82, 16, v82
v_mov_b32 v79, s8
v_mov_b32 v71, s8
s_add_u32 s14, s13, 32768
v_readfirstlane_b32 s95, v68
s_xor_b32 s95, s95, s4
s_and_b32 s9, s95, 4
s_lshl_b32 s9, s9, 11
s_add_u32 s13, s13, s9
s_add_u32 s14, s13, 0x10000
s_mov_b32 s10, 65536
s_mov_b64 vcc, -1
s_mov_b64 s[92:93], -1
L_tp52:
s_or_b64 exec, vcc, 1
buffer_load_dwordx4 v[140:143], v117, s[20:23], s13 offen sc1
s_or_b64 exec, s[92:93], 1
buffer_load_dwordx4 v[144:147], v117, s[20:23], s14 offen sc1
s_mov_b64 exec, -1
s_sub_u32 s10, s10, 1
s_cbranch_scc1 L_td53
s_waitcnt vmcnt(0)
v_max3_u32 v108, v140, v141, v142
v_max_u32 v108, v108, v143
v_cmp_eq_u32 vcc, -1, v108
v_max3_u32 v109, v144, v145, v146
v_max_u32 v109, v109, v147
v_cmp_eq_u32 s[92:93], -1, v109
s_or_b64 s[96:97], vcc, s[92:93]
s_cbranch_scc1 L_tp52
L_td53:
v_pk_add_f32 v[84:85], v[140:141], v[144:145]
v_pk_add_f32 v[86:87], v[142:143], v[146:147]
s_nop 1
v_permlane32_swap_b32 v84, v86
v_permlane32_swap_b32 v85, v87
v_pk_add_f32 v[84:85], v[84:85], v[86:87]
s_nop 1
v_permlane16_swap_b32 v84, v85
v_add_f32 v84, v84, v85
s_nop 1
v_add_f32_dpp v84, v84, v84 row_ror:4 row_mask:0xf bank_mask:0xf
s_nop 1
v_add_f32_dpp v84, v84, v84 row_ror:8 row_mask:0xf bank_mask:0xf
v_cvt_pk_bf16_f32 v84, 0, v84
s_cmp_eq_u32 s100, 2
v_mul_f32 v84, v64, v84
v_cvt_pk_bf16_f32 v84, 0, v84
v_add_f32 v78, v82, v84
v_cvt_pk_bf16_f32 v78, 0, v78
v_mul_f32 v70, 0x3b000000, v78
v_mul_f32 v85, v70, v78
s_nop 1
v_permlane32_swap_b32 v70, v85
v_add_f32 v70, v70, v85
v_mov_b32 v85, v70
s_nop 1
v_permlane16_swap_b32 v70, v85
v_add_f32 v85, v70, v85
v_mov_b32 v70, v78
s_nop 0
v_add_f32_dpp v85, v85, v85 quad_perm:[1,0,3,2] row_mask:0xf bank_mask:0xf
s_nop 1
v_add_f32_dpp v70, v85, v85 quad_perm:[2,3,0,1] row_mask:0xf bank_mask:0x2
s_mov_b32 exec_lo, 0xf001f
s_mov_b32 exec_hi, 0xf001f
s_cbranch_scc0 L_sg54
buffer_store_dwordx2 v[70:71], v73, s[20:23], s40 offen
L_sd55:
s_mov_b64 exec, -1
s_cmp_lg_u32 s7, s95
s_cbranch_scc1 L_fin2
s_mov_b32 s10, 65536
L_pl56:
buffer_load_dwordx2 v[66:67], v75, s[20:23], s39 offen sc1
s_waitcnt vmcnt(0)
v_cmp_ne_u32 vcc, s8, v67
s_cbranch_vccz L_pd57
s_sleep 4
s_sub_u32 s10, s10, 1
s_cbranch_scc0 L_pl56
L_pd57:
v_add_f32_dpp v66, v66, v66 row_ror:4 row_mask:0xf bank_mask:0xf
s_nop 1
v_add_f32_dpp v66, v66, v66 row_ror:8 row_mask:0xf bank_mask:0xf
v_cvt_pk_bf16_f32 v66, 0, v66
s_cmp_lg_u32 s100, 2
s_cbranch_scc1 L_nohint
s_mul_i32 s19, s4, 24576
s_add_u32 s19, s19, 528384
s_mov_b32 s10, 65536
s_mov_b64 vcc, -1
L_tp58:
s_mov_b64 exec, vcc
buffer_load_dwordx2 v[136:137], v121, s[20:23], s19 offen sc1
s_mov_b64 exec, -1
s_sub_u32 s10, s10, 1
s_cbranch_scc1 L_td59
s_waitcnt vmcnt(0)
v_max_u32 v108, v136, v137
v_cmp_eq_u32 vcc, -1, v108
s_cbranch_vccnz L_tp58
L_td59:
s_sleep 17
L_nohint:
s_mov_b32 s10, 65536
s_mov_b64 vcc, -1
s_mov_b64 s[92:93], -1
L_tp60:
s_or_b64 exec, vcc, 1
buffer_load_dwordx4 v[148:151], v11, s[20:23], s16 offen sc1
s_or_b64 exec, s[92:93], 1
buffer_load_dwordx4 v[152:155], v118, s[20:23], s17 offen sc1
s_mov_b64 exec, -1
s_sub_u32 s10, s10, 1
s_cbranch_scc1 L_td61
s_waitcnt vmcnt(0)
v_max3_u32 v108, v148, v149, v150
v_max_u32 v108, v108, v151
v_cmp_eq_u32 vcc, -1, v108
v_max3_u32 v109, v152, v153, v154
v_max_u32 v109, v109, v155
v_cmp_eq_u32 s[92:93], -1, v109
s_or_b64 s[96:97], vcc, s[92:93]
s_cbranch_scc1 L_tp60
L_td61:
v_pk_add_f32 v[84:85], v[148:149], v[152:153]
v_pk_add_f32 v[86:87], v[150:151], v[154:155]
s_nop 1
v_permlane32_swap_b32 v84, v86
v_permlane32_swap_b32 v85, v87
v_pk_add_f32 v[84:85], v[84:85], v[86:87]
s_nop 1
v_permlane16_swap_b32 v84, v85
v_add_f32 v84, v84, v85
s_nop 1
v_add_f32_dpp v84, v84, v84 row_ror:4 row_mask:0xf bank_mask:0xf
s_nop 1
v_add_f32_dpp v84, v84, v84 row_ror:8 row_mask:0xf bank_mask:0xf
v_cvt_pk_bf16_f32 v84, 0, v84
v_mul_f32 v84, v66, v84
v_cvt_pk_bf16_f32 v84, 0, v84
s_mov_b32 exec_lo, 0xf000f
s_mov_b32 exec_hi, 0xf000f
v_add_f32 v84, v78, v84
v_cvt_pk_bf16_f32 v84, v84, v84
buffer_store_short v84, v126, s[44:47], 0 offen
L_noep:
L_fin2:
s_endpgm
L_stream3:
v_mov_b32 v10, 1
s_mov_b64 exec, 1
ds_add_u32 v0, v10 offset:28
s_mov_b64 exec, -1
s_cmp_eq_u32 s38, 2
s_cbranch_scc1 L_qkd
s_mov_b32 s10, 1048576
L_lw62:
ds_read_b32 v2, v0 offset:8
s_waitcnt lgkmcnt(0)
v_readfirstlane_b32 s9, v2
s_cmp_ge_u32 s9, 4
s_cbranch_scc1 L_lwd63
s_sleep 1
s_sub_u32 s10, s10, 1
s_cbranch_scc0 L_lw62
L_lwd63:
s_call_b64 s[40:41], L_qk
L_qkd:
s_mov_b32 s10, 1048576
L_lw64:
ds_read_b32 v2, v0 offset:12
s_waitcnt lgkmcnt(0)
v_readfirstlane_b32 s9, v2
s_cmp_ge_u32 s9, 1
s_cbranch_scc1 L_lwd65
s_sleep 1
s_sub_u32 s10, s10, 1
s_cbranch_scc0 L_lw64
L_lwd65:
ds_read_b32 v8, v0 offset:16
ds_read_b32 v9, v0 offset:24
s_waitcnt lgkmcnt(0)
v_readfirstlane_b32 s94, v9
v_sub_f32 v5, v5, v8
v_mul_f32 v5, 0x3fb8aa3b, v5
v_exp_f32 v5, v5
s_nop 0
v_cvt_pk_bf16_f32 v5, v5, v5
v_lshlrev_b32 v2, 2, v1
v_mov_b32 v10, 1
v_and_b32_dpp v32, v5, v28 row_newbcast:0 row_mask:0xf bank_mask:0xf
v_and_b32_dpp v33, v5, v29 row_newbcast:0 row_mask:0xf bank_mask:0xf
v_and_b32_dpp v34, v5, v30 row_newbcast:0 row_mask:0xf bank_mask:0xf
v_and_b32_dpp v35, v5, v31 row_newbcast:0 row_mask:0xf bank_mask:0xf
v_and_b32_dpp v36, v5, v28 row_newbcast:1 row_mask:0xf bank_mask:0xf
v_and_b32_dpp v37, v5, v29 row_newbcast:1 row_mask:0xf bank_mask:0xf
v_and_b32_dpp v38, v5, v30 row_newbcast:1 row_mask:0xf bank_mask:0xf
v_and_b32_dpp v39, v5, v31 row_newbcast:1 row_mask:0xf bank_mask:0xf
v_and_b32_dpp v40, v5, v28 row_newbcast:2 row_mask:0xf bank_mask:0xf
v_and_b32_dpp v41, v5, v29 row_newbcast:2 row_mask:0xf bank_mask:0xf
v_and_b32_dpp v42, v5, v30 row_newbcast:2 row_mask:0xf bank_mask:0xf
v_and_b32_dpp v43, v5, v31 row_newbcast:2 row_mask:0xf bank_mask:0xf
v_and_b32_dpp v44, v5, v28 row_newbcast:3 row_mask:0xf bank_mask:0xf
v_and_b32_dpp v45, v5, v29 row_newbcast:3 row_mask:0xf bank_mask:0xf
v_and_b32_dpp v46, v5, v30 row_newbcast:3 row_mask:0xf bank_mask:0xf
v_and_b32_dpp v47, v5, v31 row_newbcast:3 row_mask:0xf bank_mask:0xf
v_and_b32_dpp v48, v5, v28 row_newbcast:4 row_mask:0xf bank_mask:0xf
v_and_b32_dpp v49, v5, v29 row_newbcast:4 row_mask:0xf bank_mask:0xf
v_and_b32_dpp v50, v5, v30 row_newbcast:4 row_mask:0xf bank_mask:0xf
v_and_b32_dpp v51, v5, v31 row_newbcast:4 row_mask:0xf bank_mask:0xf
v_and_b32_dpp v52, v5, v28 row_newbcast:5 row_mask:0xf bank_mask:0xf
v_and_b32_dpp v53, v5, v29 row_newbcast:5 row_mask:0xf bank_mask:0xf
v_and_b32_dpp v54, v5, v30 row_newbcast:5 row_mask:0xf bank_mask:0xf
v_and_b32_dpp v55, v5, v31 row_newbcast:5 row_mask:0xf bank_mask:0xf
v_and_b32_dpp v56, v5, v28 row_newbcast:6 row_mask:0xf bank_mask:0xf
v_and_b32_dpp v57, v5, v29 row_newbcast:6 row_mask:0xf bank_mask:0xf
v_and_b32_dpp v58, v5, v30 row_newbcast:6 row_mask:0xf bank_mask:0xf
v_and_b32_dpp v59, v5, v31 row_newbcast:6 row_mask:0xf bank_mask:0xf
v_and_b32_dpp v60, v5, v28 row_newbcast:7 row_mask:0xf bank_mask:0xf
v_and_b32_dpp v61, v5, v29 row_newbcast:7 row_mask:0xf bank_mask:0xf
v_and_b32_dpp v62, v5, v30 row_newbcast:7 row_mask:0xf bank_mask:0xf
v_and_b32_dpp v63, v5, v31 row_newbcast:7 row_mask:0xf bank_mask:0xf
v_and_b32_dpp v64, v5, v28 row_newbcast:8 row_mask:0xf bank_mask:0xf
v_and_b32_dpp v65, v5, v29 row_newbcast:8 row_mask:0xf bank_mask:0xf
v_and_b32_dpp v66, v5, v30 row_newbcast:8 row_mask:0xf bank_mask:0xf
v_and_b32_dpp v67, v5, v31 row_newbcast:8 row_mask:0xf bank_mask:0xf
v_and_b32_dpp v68, v5, v28 row_newbcast:9 row_mask:0xf bank_mask:0xf
v_and_b32_dpp v69, v5, v29 row_newbcast:9 row_mask:0xf bank_mask:0xf
v_and_b32_dpp v70, v5, v30 row_newbcast:9 row_mask:0xf bank_mask:0xf
v_and_b32_dpp v71, v5, v31 row_newbcast:9 row_mask:0xf bank_mask:0xf
v_and_b32_dpp v72, v5, v28 row_newbcast:10 row_mask:0xf bank_mask:0xf
v_and_b32_dpp v73, v5, v29 row_newbcast:10 row_mask:0xf bank_mask:0xf
v_and_b32_dpp v74, v5, v30 row_newbcast:10 row_mask:0xf bank_mask:0xf
v_and_b32_dpp v75, v5, v31 row_newbcast:10 row_mask:0xf bank_mask:0xf
v_and_b32_dpp v76, v5, v28 row_newbcast:11 row_mask:0xf bank_mask:0xf
v_and_b32_dpp v77, v5, v29 row_newbcast:11 row_mask:0xf bank_mask:0xf
v_and_b32_dpp v78, v5, v30 row_newbcast:11 row_mask:0xf bank_mask:0xf
v_and_b32_dpp v79, v5, v31 row_newbcast:11 row_mask:0xf bank_mask:0xf
v_and_b32_dpp v80, v5, v28 row_newbcast:12 row_mask:0xf bank_mask:0xf
v_and_b32_dpp v81, v5, v29 row_newbcast:12 row_mask:0xf bank_mask:0xf
v_and_b32_dpp v82, v5, v30 row_newbcast:12 row_mask:0xf bank_mask:0xf
v_and_b32_dpp v83, v5, v31 row_newbcast:12 row_mask:0xf bank_mask:0xf
v_and_b32_dpp v84, v5, v28 row_newbcast:13 row_mask:0xf bank_mask:0xf
v_and_b32_dpp v85, v5, v29 row_newbcast:13 row_mask:0xf bank_mask:0xf
v_and_b32_dpp v86, v5, v30 row_newbcast:13 row_mask:0xf bank_mask:0xf
v_and_b32_dpp v87, v5, v31 row_newbcast:13 row_mask:0xf bank_mask:0xf
v_and_b32_dpp v88, v5, v28 row_newbcast:14 row_mask:0xf bank_mask:0xf
v_and_b32_dpp v89, v5, v29 row_newbcast:14 row_mask:0xf bank_mask:0xf
v_and_b32_dpp v90, v5, v30 row_newbcast:14 row_mask:0xf bank_mask:0xf
v_and_b32_dpp v91, v5, v31 row_newbcast:14 row_mask:0xf bank_mask:0xf
v_and_b32_dpp v92, v5, v28 row_newbcast:15 row_mask:0xf bank_mask:0xf
v_and_b32_dpp v93, v5, v29 row_newbcast:15 row_mask:0xf bank_mask:0xf
v_and_b32_dpp v94, v5, v30 row_newbcast:15 row_mask:0xf bank_mask:0xf
v_and_b32_dpp v95, v5, v31 row_newbcast:15 row_mask:0xf bank_mask:0xf
v_mfma_f32_16x16x32_bf16 v[12:15], v[32:35], v[96:99], 0
v_mfma_f32_16x16x32_bf16 v[12:15], v[36:39], v[100:103], v[12:15]
v_mfma_f32_16x16x32_bf16 v[12:15], v[40:43], v[104:107], v[12:15]
v_mfma_f32_16x16x32_bf16 v[12:15], v[44:47], v[108:111], v[12:15]
v_mfma_f32_16x16x32_bf16 v[12:15], v[48:51], v[112:115], v[12:15]
v_mfma_f32_16x16x32_bf16 v[12:15], v[52:55], v[116:119], v[12:15]
v_mfma_f32_16x16x32_bf16 v[12:15], v[56:59], v[120:123], v[12:15]
v_mfma_f32_16x16x32_bf16 v[12:15], v[60:63], v[124:127], v[12:15]
v_mfma_f32_16x16x32_bf16 v[12:15], v[64:67], v[128:131], v[12:15]
v_mfma_f32_16x16x32_bf16 v[12:15], v[68:71], v[132:135], v[12:15]
s_waitcnt vmcnt(5)
v_mfma_f32_16x16x32_bf16 v[12:15], v[72:75], v[136:139], v[12:15]
s_waitcnt vmcnt(4)
v_mfma_f32_16x16x32_bf16 v[12:15], v[76:79], v[140:143], v[12:15]
s_waitcnt vmcnt(3)
v_mfma_f32_16x16x32_bf16 v[12:15], v[80:83], v[144:147], v[12:15]
s_waitcnt vmcnt(2)
s_mov_b64 exec, 1
ds_add_u32 v0, v10 offset:48
s_mov_b64 exec, -1
v_mfma_f32_16x16x32_bf16 v[12:15], v[84:87], v[148:151], v[12:15]
s_waitcnt vmcnt(1)
v_mfma_f32_16x16x32_bf16 v[12:15], v[88:91], v[152:155], v[12:15]
s_waitcnt vmcnt(0)
v_mfma_f32_16x16x32_bf16 v[12:15], v[92:95], v[156:159], v[12:15]
s_mov_b32 exec_lo, 0xffffffff
s_mov_b32 exec_hi, 0x0
s_nop 5
ds_write_b128 v4, v[12:15] offset:5120
s_mov_b64 exec, 1
ds_add_rtn_u32 v11, v0, v10 offset:140
s_mov_b64 exec, -1
ds_read_b128 v[32:35], v6 offset:5120
ds_read_b128 v[36:39], v6 offset:6144
ds_read_b128 v[40:43], v6 offset:7168
ds_read_b128 v[44:47], v6 offset:8192
s_waitcnt lgkmcnt(4)
v_readfirstlane_b32 s9, v11
s_cmp_lg_u32 s9, 7
s_cbranch_scc1 L_done
s_cmp_eq_u32 s94, 2
s_waitcnt lgkmcnt(2)
v_pk_add_f32 v[32:33], v[32:33], v[36:37]
v_pk_add_f32 v[34:35], v[34:35], v[38:39]
s_waitcnt lgkmcnt(0)
v_pk_add_f32 v[40:41], v[40:41], v[44:45]
v_pk_add_f32 v[42:43], v[42:43], v[46:47]
v_permlane32_swap_b32 v32, v34
v_permlane32_swap_b32 v33, v35
v_permlane32_swap_b32 v40, v42
v_permlane32_swap_b32 v41, v43
v_pk_add_f32 v[32:33], v[32:33], v[34:35]
v_pk_add_f32 v[40:41], v[40:41], v[42:43]
s_nop 0
v_permlane16_swap_b32 v32, v33
v_permlane16_swap_b32 v40, v41
v_add_f32 v32, v32, v33
v_add_f32 v40, v40, v41
s_cbranch_scc0 L_sg66
buffer_store_dword v32, v2, s[20:23], s29 offen
L_sd67:
s_cbranch_scc0 L_sg68
buffer_store_dword v40, v2, s[20:23], s29 offen offset:256
L_sd69:
ds_write2st64_b32 v2, v32, v40 offset0:12 offset1:13
v_mov_b32 v10, 8
s_mov_b64 exec, 1
ds_add_u32 v0, v10 offset:140
s_mov_b64 exec, -1
s_endpgm
L_qk:
v_and_b32 v3, 15, v1
v_lshlrev_b32 v3, 4, v3
ds_read_b128 v[24:27], v3 offset:256
s_mov_b32 s38, 2
s_and_b32 s4, s2, 7
s_lshr_b32 s5, s2, 3
s_lshl_b32 s6, s4, 2
s_and_b32 s7, s5, 3
s_add_u32 s6, s6, s7
s_lshr_b32 s7, s5, 2
s_mov_b32 s11, 0xffff0000
s_mov_b32 s22, 0x10000000
s_mov_b32 s23, 0x20000
s_mov_b64 s[20:21], s[90:91]
v_and_b32 v2, 1, v1
v_lshlrev_b32 v2, 4, v2
v_mov_b32 v3, 0xffff
v_lshlrev_b32 v2, v2, v3
v_bfe_u32 v3, v1, 1, 2
v_cmp_eq_u32 vcc, 0, v3
s_nop 1
v_cndmask_b32 v28, 0, v2, vcc
v_cmp_eq_u32 vcc, 1, v3
s_nop 1
v_cndmask_b32 v29, 0, v2, vcc
v_cmp_eq_u32 vcc, 2, v3
s_nop 1
v_cndmask_b32 v30, 0, v2, vcc
v_cmp_eq_u32 vcc, 3, v3
s_nop 1
v_cndmask_b32 v31, 0, v2, vcc
s_mov_b32 s30, 0xaaaaaaaa
s_mov_b32 s31, 0xaaaaaaaa
s_mov_b32 s32, 0xcccccccc
s_mov_b32 s33, 0xcccccccc
v_and_b32 v4, 16, v1
v_and_b32 v2, 7, v1
v_lshl_add_u32 v4, v2, 5, v4
v_and_b32 v2, 8, v1
v_lshl_add_u32 v4, v2, 8, v4
s_lshl_b32 s9, s26, 8
v_add_u32 v4, s9, v4
s_lshl_b32 s9, s26, 11
v_add_u32 v7, s9, v6
s_mul_i32 s29, s6, 6144
s_lshl_b32 s10, s7, 9
s_add_u32 s29, s29, s10
s_add_u32 s29, s29, 524288
s_lshl_b32 s36, s26, 3
s_waitcnt lgkmcnt(0)
v_dot2_f32_bf16 v8, v32, v24, 0
v_dot2_f32_bf16 v9, v36, v24, 0
v_dot2_f32_bf16 v10, v40, v24, 0
v_dot2_f32_bf16 v11, v44, v24, 0
v_dot2_f32_bf16 v12, v48, v24, 0
v_dot2_f32_bf16 v13, v52, v24, 0
v_dot2_f32_bf16 v14, v56, v24, 0
v_dot2_f32_bf16 v15, v60, v24, 0
v_dot2_f32_bf16 v16, v64, v24, 0
v_dot2_f32_bf16 v17, v68, v24, 0
v_dot2_f32_bf16 v18, v72, v24, 0
v_dot2_f32_bf16 v19, v76, v24, 0
v_dot2_f32_bf16 v20, v80, v24, 0
v_dot2_f32_bf16 v21, v84, v24, 0
v_dot2_f32_bf16 v22, v88, v24, 0
v_dot2_f32_bf16 v23, v92, v24, 0
v_dot2c_f32_bf16 v8, v33, v25
v_dot2c_f32_bf16 v9, v37, v25
v_dot2c_f32_bf16 v10, v41, v25
v_dot2c_f32_bf16 v11, v45, v25
v_dot2c_f32_bf16 v12, v49, v25
v_dot2c_f32_bf16 v13, v53, v25
v_dot2c_f32_bf16 v14, v57, v25
v_dot2c_f32_bf16 v15, v61, v25
v_dot2c_f32_bf16 v16, v65, v25
v_dot2c_f32_bf16 v17, v69, v25
v_dot2c_f32_bf16 v18, v73, v25
v_dot2c_f32_bf16 v19, v77, v25
v_dot2c_f32_bf16 v20, v81, v25
v_dot2c_f32_bf16 v21, v85, v25
v_dot2c_f32_bf16 v22, v89, v25
v_dot2c_f32_bf16 v23, v93, v25
v_dot2c_f32_bf16 v8, v34, v26
v_dot2c_f32_bf16 v9, v38, v26
v_dot2c_f32_bf16 v10, v42, v26
v_dot2c_f32_bf16 v11, v46, v26
v_dot2c_f32_bf16 v12, v50, v26
v_dot2c_f32_bf16 v13, v54, v26
v_dot2c_f32_bf16 v14, v58, v26
v_dot2c_f32_bf16 v15, v62, v26
v_dot2c_f32_bf16 v16, v66, v26
v_dot2c_f32_bf16 v17, v70, v26
v_dot2c_f32_bf16 v18, v74, v26
v_dot2c_f32_bf16 v19, v78, v26
v_dot2c_f32_bf16 v20, v82, v26
v_dot2c_f32_bf16 v21, v86, v26
v_dot2c_f32_bf16 v22, v90, v26
v_dot2c_f32_bf16 v23, v94, v26
v_dot2c_f32_bf16 v8, v35, v27
v_dot2c_f32_bf16 v9, v39, v27
v_dot2c_f32_bf16 v10, v43, v27
v_dot2c_f32_bf16 v11, v47, v27
v_dot2c_f32_bf16 v12, v51, v27
v_dot2c_f32_bf16 v13, v55, v27
v_dot2c_f32_bf16 v14, v59, v27
v_dot2c_f32_bf16 v15, v63, v27
v_dot2c_f32_bf16 v16, v67, v27
v_dot2c_f32_bf16 v17, v71, v27
v_dot2c_f32_bf16 v18, v75, v27
v_dot2c_f32_bf16 v19, v79, v27
v_dot2c_f32_bf16 v20, v83, v27
v_dot2c_f32_bf16 v21, v87, v27
v_dot2c_f32_bf16 v22, v91, v27
v_dot2c_f32_bf16 v23, v95, v27
v_add_f32_dpp v8, v8, v8 row_ror:8 row_mask:0xf bank_mask:0x3
v_add_f32_dpp v9, v9, v9 row_ror:8 row_mask:0xf bank_mask:0x3
v_add_f32_dpp v10, v10, v10 row_ror:8 row_mask:0xf bank_mask:0x3
v_add_f32_dpp v11, v11, v11 row_ror:8 row_mask:0xf bank_mask:0x3
v_add_f32_dpp v12, v12, v12 row_ror:8 row_mask:0xf bank_mask:0x3
v_add_f32_dpp v13, v13, v13 row_ror:8 row_mask:0xf bank_mask:0x3
v_add_f32_dpp v14, v14, v14 row_ror:8 row_mask:0xf bank_mask:0x3
v_add_f32_dpp v15, v15, v15 row_ror:8 row_mask:0xf bank_mask:0x3
v_add_f32_dpp v8, v16, v16 row_ror:8 row_mask:0xf bank_mask:0xc
v_add_f32_dpp v9, v17, v17 row_ror:8 row_mask:0xf bank_mask:0xc
v_add_f32_dpp v10, v18, v18 row_ror:8 row_mask:0xf bank_mask:0xc
v_add_f32_dpp v11, v19, v19 row_ror:8 row_mask:0xf bank_mask:0xc
v_add_f32_dpp v12, v20, v20 row_ror:8 row_mask:0xf bank_mask:0xc
v_add_f32_dpp v13, v21, v21 row_ror:8 row_mask:0xf bank_mask:0xc
v_add_f32_dpp v14, v22, v22 row_ror:8 row_mask:0xf bank_mask:0xc
v_add_f32_dpp v15, v23, v23 row_ror:8 row_mask:0xf bank_mask:0xc
v_add_f32_dpp v8, v8, v8 row_shl:4 row_mask:0xf bank_mask:0x5
v_add_f32_dpp v9, v9, v9 row_shl:4 row_mask:0xf bank_mask:0x5
v_add_f32_dpp v10, v10, v10 row_shl:4 row_mask:0xf bank_mask:0x5
v_add_f32_dpp v11, v11, v11 row_shl:4 row_mask:0xf bank_mask:0x5
v_add_f32_dpp v8, v12, v12 row_shr:4 row_mask:0xf bank_mask:0xa
v_add_f32_dpp v9, v13, v13 row_shr:4 row_mask:0xf bank_mask:0xa
v_add_f32_dpp v10, v14, v14 row_shr:4 row_mask:0xf bank_mask:0xa
v_add_f32_dpp v11, v15, v15 row_shr:4 row_mask:0xf bank_mask:0xa
v_add_f32_dpp v8, v8, v8 quad_perm:[1,0,3,2] row_mask:0xf bank_mask:0xf
v_add_f32_dpp v9, v9, v9 quad_perm:[1,0,3,2] row_mask:0xf bank_mask:0xf
v_add_f32_dpp v10, v10, v10 quad_perm:[1,0,3,2] row_mask:0xf bank_mask:0xf
v_add_f32_dpp v11, v11, v11 quad_perm:[1,0,3,2] row_mask:0xf bank_mask:0xf
v_add_f32_dpp v8, v8, v8 quad_perm:[2,3,0,1] row_mask:0xf bank_mask:0xf
v_add_f32_dpp v9, v9, v9 quad_perm:[2,3,0,1] row_mask:0xf bank_mask:0xf
v_add_f32_dpp v10, v10, v10 quad_perm:[2,3,0,1] row_mask:0xf bank_mask:0xf
v_add_f32_dpp v11, v11, v11 quad_perm:[2,3,0,1] row_mask:0xf bank_mask:0xf
v_cndmask_b32 v8, v8, v9, s[30:31]
v_cndmask_b32 v10, v10, v11, s[30:31]
v_cndmask_b32 v5, v8, v10, s[32:33]
v_cvt_pk_bf16_f32 v5, 0, v5
v_mul_f32 v5, 0x3db504f3, v5
v_cvt_pk_bf16_f32 v5, 0, v5
v_mov_b32 v8, v5
s_nop 1
v_max_f32_dpp v8, v8, v8 row_ror:8 row_mask:0xf bank_mask:0xf
s_nop 1
v_max_f32_dpp v8, v8, v8 row_ror:4 row_mask:0xf bank_mask:0xf
s_nop 1
v_max_f32_dpp v8, v8, v8 row_ror:2 row_mask:0xf bank_mask:0xf
s_nop 1
v_max_f32_dpp v8, v8, v8 row_ror:1 row_mask:0xf bank_mask:0xf
v_mov_b32 v10, v8
s_nop 1
v_permlane16_swap_b32 v8, v10
v_max_f32 v8, v8, v10
v_mov_b32 v10, v8
s_nop 1
v_permlane32_swap_b32 v8, v10
v_max_f32 v8, v8, v10
v_sub_f32 v9, v5, v8
v_mul_f32 v9, 0x3fb8aa3b, v9
v_exp_f32 v9, v9
s_nop 1
v_add_f32_dpp v9, v9, v9 row_ror:8 row_mask:0xf bank_mask:0xf
s_nop 1
v_add_f32_dpp v9, v9, v9 row_ror:4 row_mask:0xf bank_mask:0xf
s_nop 1
v_add_f32_dpp v9, v9, v9 row_ror:2 row_mask:0xf bank_mask:0xf
s_nop 1
v_add_f32_dpp v9, v9, v9 row_ror:1 row_mask:0xf bank_mask:0xf
v_mov_b32 v10, v9
s_nop 1
v_permlane16_swap_b32 v9, v10
v_add_f32 v9, v9, v10
v_mov_b32 v10, v9
s_nop 1
v_permlane32_swap_b32 v9, v10
v_add_f32 v9, v9, v10
v_mov_b32 v10, s36
v_mov_b32 v11, 1
s_mov_b64 exec, 1
ds_write_b64 v10, v[8:9] offset:64
ds_add_u32 v0, v11 offset:32
s_mov_b64 exec, -1
s_setpc_b64 s[40:41]
L_sg13:
s_nop 4
buffer_store_dwordx4 v[112:115], v11, s[20:23], s9 offen sc1
s_nop 1
s_branch L_sd14
L_sg21:
s_nop 4
buffer_store_dwordx4 v[16:19], v108, s[20:23], s42 offen sc1
s_nop 1
s_branch L_sd22
L_sg27:
s_nop 4
buffer_store_dwordx4 v[88:91], v0, s[20:23], s9 offen sc1
s_nop 1
s_branch L_sd28
L_sg45:
s_nop 4
buffer_store_dword v84, v114, s[20:23], s42 offen sc1
s_nop 1
s_branch L_sd46
L_sg54:
s_nop 4
buffer_store_dwordx2 v[70:71], v73, s[20:23], s40 offen sc1
s_nop 1
s_branch L_sd55
L_sg66:
s_nop 4
buffer_store_dword v32, v2, s[20:23], s29 offen sc1
s_nop 1
s_branch L_sd67
L_sg68:
s_nop 4
buffer_store_dword v40, v2, s[20:23], s29 offen offset:256 sc1
s_nop 1
s_branch L_sd69
L_done:
s_endpgm
.section .rodata,"a"
.p2align 6
.amdhsa_kernel adaLN_cond__gqa_block_cached__glu_gated_bilinear__decode_kernel
  .amdhsa_next_free_vgpr 168
  .amdhsa_next_free_sgpr 102
  .amdhsa_accum_offset 168
  .amdhsa_group_segment_fixed_size 0
  .amdhsa_kernarg_size 112
  .amdhsa_user_sgpr_count 2
  .amdhsa_user_sgpr_kernarg_segment_ptr 1
  .amdhsa_system_sgpr_workgroup_id_x 1
  .amdhsa_float_denorm_mode_32 3
.end_amdhsa_kernel
```
